```python
import torch

def _softmax(x, axis=-1):
    return torch.softmax(x, dim=axis)
def _gelu(x):
    return torch.nn.functional.gelu(x, approximate="tanh")
def _silu(x):
    return torch.nn.functional.silu(x)
def _sigmoid(x):
    return torch.sigmoid(x)
def _layernorm(x, axis=-1, eps=1e-5):
    m = x.mean(dim=axis, keepdim=True)
    v = x.var(dim=axis, keepdim=True, unbiased=False)
    return (x - m) / torch.sqrt(v + eps)
def _scatter_add(tgt, idx, src, axis=0):
    return tgt.clone().index_add_(axis, idx, src)
def _segment_sum(src, seg, n):
    out = torch.zeros((n,) + src.shape[1:], dtype=src.dtype)
    return out.index_add_(0, seg, src)
def _pad(x, pw):
    flat = tuple(v for pair in reversed(pw) for v in pair)
    return torch.nn.functional.pad(x, flat)

kernel_name = 'parallel_sum__softmax_full_mha__swiglu_ffn__prompt'

def setup_inputs():

    _w = (lambda a: (lambda t: t.to(torch.bfloat16) if t.is_floating_point() else t)(torch.as_tensor(a)))
    def _A_setup():
        B, S, D = 1, 2048, 512
        return {
            "x": _w((lambda *s: torch.randn(*s, dtype=torch.bfloat16) * 0.05)(B, S, D)),
            "wqkv": _w((lambda *s: torch.randn(*s, dtype=torch.bfloat16) * 0.2)(D, 3 * D)),
            "wo": _w((lambda *s: torch.randn(*s, dtype=torch.bfloat16) * 0.1)(D, D)),
        }
    _A_in = _A_setup()

    def _B_setup():
        B, S, D, F = 1, 2048, 512, 1792
        return {
            "x": _w((lambda *s: torch.randn(*s, dtype=torch.bfloat16) * 0.05)(B, S, D)),
            "w_gate": _w((lambda *s: torch.randn(*s, dtype=torch.bfloat16) * 0.1)(D, F)),
            "w_up": _w((lambda *s: torch.randn(*s, dtype=torch.bfloat16) * 0.1)(D, F)),
            "w_down": _w((lambda *s: torch.randn(*s, dtype=torch.bfloat16) * 0.1)(F, D)),
        }
    _B_in = _B_setup()

    return {
        "A_x": _A_in["x"],
        "A_wqkv": _A_in["wqkv"],
        "A_wo": _A_in["wo"],
        "B_x": _B_in["x"],
        "B_w_gate": _B_in["w_gate"],
        "B_w_up": _B_in["w_up"],
        "B_w_down": _B_in["w_down"],
    }

def reference(A_x, A_wqkv, A_wo, B_x, B_w_gate, B_w_up, B_w_down):
    def _A_ref(x, wqkv, wo):
        B, S, D = x.shape
        H = 32; Dh = D // H
        qkv = (lambda x, *d: x.permute(*d))((x @ wqkv).reshape(B, S, 3, H, Dh), 2, 0, 3, 1, 4)
        q, k, v = qkv[0], qkv[1], qkv[2]
        scale = Dh ** -0.5
        scores = torch.einsum("bhqd,bhkd->bhqk", q, k) * scale
        p = _softmax(scores, axis=-1)
        o = torch.einsum("bhqk,bhkd->bhqd", p, v)
        return (lambda x, *d: x.permute(*d))(o, 0, 2, 1, 3).reshape(B, S, D) @ wo

    def _B_ref(x, w_gate, w_up, w_down):
        g = _silu(x @ w_gate)
        u = x @ w_up
        return (g * u) @ w_down

    x = A_x
    xn = _layernorm(x, axis=-1)
    return x + _A_ref(xn, A_wqkv, A_wo) + _B_ref(xn, B_w_gate, B_w_up, B_w_down)
```

```asm
; @launch grid=(256,1,1) block=(512,1,1) lds=163840
.amdgcn_target "amdgcn-amd-amdhsa--gfx950"
.text
.globl parallel_sum__softmax_full_mha__swiglu_ffn__prompt_kernel
.p2align 8
.type parallel_sum__softmax_full_mha__swiglu_ffn__prompt_kernel,@function
parallel_sum__softmax_full_mha__swiglu_ffn__prompt_kernel:
    s_cmp_ge_u32 s2, 256
    s_cbranch_scc1 L_end
    s_getpc_b64 s[36:37]
L_pc:
    s_load_dwordx2 s[4:5], s[0:1], 0
    v_lshlrev_b32 v3, 7, v0
    v_cmp_gt_u32 vcc, 24, v0
    s_and_saveexec_b64 s[70:71], vcc
    s_cbranch_execz L_nc0
    global_load_dword v95, v3, s[36:37] offset:128
L_nc0:
    s_mov_b64 exec, -1
    v_lshrrev_b32 v2, 6, v0
    v_and_b32 v40, 63, v0
    v_readfirstlane_b32 s46, v2
    s_load_dwordx2 s[8:9], s[0:1], 8
    s_load_dwordx2 s[12:13], s[0:1], 32
    s_load_dwordx2 s[16:17], s[0:1], 40
    s_load_dwordx2 s[32:33], s[0:1], 72
    s_mov_b32 s6, 2097152
    s_mov_b32 s7, 0x00020000
    s_and_b32 s40, s2, 1
    s_bfe_u32 s51, s2, 0x30003
    s_lshl3_add_u32 s40, s40, s51
    s_lshr_b32 s61, s2, 6
    s_lshl1_add_u32 s49, s61, s40
    s_and_b32 s47, s46, 3
    s_lshr_b32 s48, s46, 2
    s_lshl2_add_u32 s59, s40, s47
    s_lshl1_add_u32 s55, s59, s48
    s_lshl_b32 s55, s55, 14
    s_lshl1_add_u32 s54, s47, s48
    s_lshl_b32 s54, s54, 11
    v_lshrrev_b32 v2, 3, v40
    v_lshlrev_b32 v4, 10, v2
    v_lshrrev_b32 v3, 4, v40
    v_and_b32 v41, 7, v40
    v_xor_b32 v3, v3, v41
    v_lshl_add_u32 v64, v3, 4, v4
    v_xor_b32 v65, 64, v64
    v_add_u32 v65, 7168, v65
    s_waitcnt lgkmcnt(0)
    s_add_u32 s53, s49, 0
    s_and_b32 s53, s53, 7
    s_lshl_b32 s51, s53, 7
    s_add_u32 m0, s54, 24576
    s_add_u32 s51, s51, s55
    buffer_load_dwordx4 v64, s[4:7], s51 offen lds
    s_add_u32 m0, s54, 24576
    s_lshl3_add_u32 s53, s53, s46
    buffer_load_dwordx4 v65, s[4:7], s51 offen offset:1024 lds
    s_load_dwordx2 s[20:21], s[0:1], 48
    s_load_dwordx2 s[24:25], s[0:1], 16
    s_load_dwordx2 s[28:29], s[0:1], 56
    s_mov_b32 s10, 1572864
    s_mov_b32 s11, s7
    s_bfe_u32 s62, s2, 0x20001
    s_mul_i32 s41, s62, 3
    s_add_u32 s41, s41, s61
    s_add_u32 s60, s62, 12
    s_cmp_eq_u32 s61, 3
    s_cselect_b32 s41, s60, s41
    s_lshl_b32 s83, s41, 7
    s_lshr_b32 s60, s46, 1
    s_lshl2_add_u32 s85, s60, s46
    s_lshl_b32 s85, s85, 10
    v_bfe_u32 v3, v40, 2, 1
    v_bfe_u32 v5, v40, 4, 1
    v_xor_b32 v3, v3, v5
    v_lshlrev_b32 v3, 2, v3
    v_and_or_b32 v3, v40, 3, v3
    v_mul_u32_u24 v66, 3072, v2
    v_lshl_add_u32 v66, v3, 4, v66
    s_mul_i32 s52, s53, 24576
    s_add_u32 m0, s85, 0
    s_add_u32 s51, s52, s83
    buffer_load_dwordx4 v66, s[8:11], s51 offen lds
    s_mov_b32 s14, 1835008
    s_mov_b32 s15, s7
    s_mov_b32 s18, 1835008
    s_mov_b32 s19, s7
    s_mov_b32 s34, 33554432
    s_mov_b32 s35, s7
    s_lshl_b32 s60, s41, 8
    s_sub_u32 s60, s60, 1024
    s_cmp_ge_u32 s41, 12
    s_cselect_b32 s68, s60, s83
    v_lshl_add_u32 v4, v3, 4, v4
    v_mul_u32_u24 v2, 3584, v2
    v_and_b32 v3, 1, v40
    v_lshl_add_u32 v2, v3, 4, v2
    v_bfe_u32 v3, v40, 1, 2
    v_xor_b32 v3, v3, v5
    v_lshl_add_u32 v120, v3, 5, v2
    v_xor_b32 v121, 64, v120
    v_lshlrev_b32 v6, 4, v40
    s_cbranch_scc1 L_sp_R
    s_mul_i32 s52, s53, 28672
    s_add_u32 m0, s85, 2048
    s_add_u32 s51, s52, s68
    buffer_load_dwordx4 v120, s[12:15], s51 offen lds
    s_add_u32 m0, s85, 4096
    s_nop 0
    buffer_load_dwordx4 v121, s[16:19], s51 offen lds
    s_branch L_sp_d
L_sp_R:
    s_add_u32 m0, s85, 2048
    s_add_u32 s51, s52, s68
    buffer_load_dwordx4 v66, s[8:11], s51 offen lds
    s_add_u32 m0, s85, 4096
    s_add_u32 s51, s51, 128
    buffer_load_dwordx4 v66, s[8:11], s51 offen lds
L_sp_d:
    s_lshl4_add_u32 s94, s40, s41
    s_lshl3_add_u32 s94, s94, s46
    s_lshl_b32 s53, s94, 10
    s_mov_b32 s51, 21020672
    buffer_load_dwordx4 v[88:91], v6, s[4:7], s53 offen
    s_mov_b64 exec, 1
    buffer_load_dword v92, off, s[32:35], s51 sc1
    s_mov_b64 exec, -1
    s_lshr_b32 s43, s2, 3
    s_and_b32 s67, s2, 7
    s_cmp_lg_u32 s46, 7
    s_cbranch_scc1 L_nocpf
    s_lshl_b32 s51, s43, 3
    v_add_lshl_u32 v2, v40, s51, 7
    v_min_u32 v2, L_end-L_pc, v2
    s_mov_b64 exec, 0xff
    global_load_dword v95, v2, s[36:37]
    s_mov_b64 exec, -1
L_nocpf:
    s_waitcnt lgkmcnt(0)
    s_mov_b32 s22, 1835008
    s_mov_b32 s23, s7
    s_mov_b32 s26, 524288
    s_mov_b32 s27, s7
    s_mov_b32 s30, 2097152
    s_mov_b32 s31, s7
    s_and_b32 s51, s43, 7
    s_and_b32 s44, s67, 3
    s_lshl3_add_u32 s44, s44, s51
    s_lshr_b32 s45, s67, 2
    s_lshl2_add_u32 s45, s45, s61
    s_and_b32 s51, s43, 3
    s_lshl2_add_u32 s42, s67, s51
    s_lshr_b32 s43, s43, 2
    s_add_u32 s69, s83, 1536
    s_lshl_b32 s86, s46, 12
    s_add_u32 s90, s49, s48
    s_mov_b32 s66, 0x40000
    s_mov_b32 s58, 0x3f803f80
    s_mov_b32 s70, 0xffff
    s_mov_b32 s71, 0xffff
    s_mov_b32 s60, 0xbe800000
    s_mov_b32 s87, 0xbf317218
    s_cmp_lt_u32 s41, 8
    s_cselect_b32 s87, s60, s87
    s_lshl_b32 s51, s59, 10
    s_lshl_b32 s60, s48, 17
    s_add_u32 s51, s51, s60
    s_lshl_b32 s64, s41, 18
    s_add_u32 s64, s64, s51
    s_lshl_b32 s52, s68, 11
    s_add_u32 s52, s52, s51
    s_mul_i32 s51, s59, 147456
    s_lshl_b32 s60, s48, 11
    s_add_u32 s51, s51, s60
    s_lshl_b32 s60, s83, 5
    s_add_u32 s51, s51, s60
    s_add_u32 s88, s51, 8388608
    s_add_u32 s73, s88, 49152
    s_cmp_ge_u32 s41, 12
    s_cselect_b32 s88, s52, s88
    s_lshl1_add_u32 s60, s41, s48
    s_lshl_b32 s60, s60, 13
    s_add_u32 s60, s60, 21495808
    s_lshl_b32 s51, s40, 9
    s_add_u32 s92, s60, s51
    s_and_b32 s51, s51, 4096
    s_add_u32 s93, s60, s51
    s_lshl3_add_u32 s82, s43, s46
    s_lshl_b32 s56, s42, 16
    s_lshl_b32 s62, s82, 10
    s_add_u32 s62, s62, s56
    s_add_u32 s56, s56, 2097152
    s_mul_i32 s60, s48, 2095104
    s_add_u32 s61, s56, s60
    s_lshl_b32 s60, s47, 10
    s_add_u32 s61, s61, s60
    s_add_u32 s61, s61, 1024
    s_lshl_b32 s65, s46, 10
    s_lshl_b32 s57, s46, 11
    s_add_u32 s72, s57, 98304
    s_add_u32 s57, s57, 32768
    s_lshl_b32 s63, s46, 14
    s_lshl_b32 s60, s45, 7
    s_add_u32 s63, s63, s60
    s_mul_i32 s80, s44, 294912
    s_add_u32 s80, s80, s65
    s_add_u32 s80, s80, 8388608
    s_add_u32 s89, s80, 146432
    s_lshl_b32 s52, s48, 13
    s_bfe_u32 s60, s46, 0x10001
    s_lshl_b32 s60, s60, 10
    s_add_u32 s84, s52, s60
    s_add_u32 s84, s84, 98304
    s_mov_b32 s36, s20
    s_mov_b32 s37, s21
    s_mov_b32 s38, s22
    s_mov_b32 s39, s23
    s_lshl_b32 s95, s67, 11
    s_add_u32 s95, s95, 20971520
    s_add_u32 s96, s95, 16384
    s_lshr_b32 s97, s67, 1
    s_lshl_b32 s97, s97, 11
    s_add_u32 s97, s97, 20996096
    v_and_b32 v2, 31, v40
    v_bfe_u32 v3, v40, 1, 3
    v_lshrrev_b32 v41, 5, v40
    v_xor_b32 v3, v3, v41
    s_lshl_b32 s51, s47, 12
    s_add_u32 s51, s51, 24576
    v_lshlrev_b32 v2, 7, v2
    v_add_u32 v2, s51, v2
    v_lshl_add_u32 v68, v3, 4, v2
    v_xor_b32 v69, 32, v68
    v_xor_b32 v70, 64, v68
    v_xor_b32 v71, 96, v68
    v_bfe_u32 v2, v40, 2, 2
    v_and_b32 v42, 3, v40
    v_lshlrev_b32 v42, 3, v42
    v_lshl_add_u32 v42, v2, 7, v42
    v_lshl_add_u32 v3, v41, 10, v42
    v_lshrrev_b32 v2, 1, v2
    v_xor_b32 v67, s48, v2
    v_lshl_add_u32 v67, v67, 6, v3
    v_lshl_add_u32 v67, v5, 5, v67
    s_and_b32 s60, s46, 1
    s_add_u32 s52, s52, 32768
    v_xor_b32 v1, s60, v2
    v_lshl_add_u32 v1, v1, 6, v42
    v_lshl_add_u32 v1, v41, 9, v1
    v_lshl_add_u32 v1, v5, 5, v1
    v_add_u32 v1, s52, v1
    v_lshl_add_u32 v3, v5, 11, v3
    v_lshl_add_u32 v2, v5, 1, v2
    s_lshl_b32 s51, s48, 1
    v_xor_b32 v2, s51, v2
    v_lshl_add_u32 v8, v2, 5, v3
    v_xor_b32 v9, 32, v8
    v_mov_b32 v10, s58
    v_mov_b32 v11, s58
    v_and_b32 v2, 0x2ff, v6
    v_lshl_add_u32 v2, v5, 16, v2
    s_lshl_b32 s60, s46, 7
    s_add_u32 s60, s60, 38912
    v_lshl_add_u32 v5, v41, 4, s60
    v_and_b32 v93, 31, v40
    v_lshlrev_b32 v94, 4, v93
    v_lshl_add_u32 v93, v93, 2, s60
    v_mov_b32 v72, 0
    v_mov_b32 v73, 0
    s_cmp_ge_u32 s41, 12
    s_cbranch_scc1 L_tib_R
    s_add_u32 s53, s49, 1
    s_and_b32 s53, s53, 7
    s_lshl_b32 s51, s53, 7
    s_add_u32 m0, s54, 65536
    s_add_u32 s51, s51, s55
    buffer_load_dwordx4 v64, s[4:7], s51 offen lds
    s_add_u32 m0, s54, 65536
    s_lshl3_add_u32 s53, s53, s46
    buffer_load_dwordx4 v65, s[4:7], s51 offen offset:1024 lds
    s_mul_i32 s52, s53, 24576
    s_add_u32 m0, s85, 40960
    s_add_u32 s51, s52, s83
    buffer_load_dwordx4 v66, s[8:11], s51 offen lds
    s_mul_i32 s52, s53, 28672
    s_add_u32 m0, s85, 43008
    s_add_u32 s51, s52, s68
    buffer_load_dwordx4 v120, s[12:15], s51 offen lds
    s_add_u32 m0, s85, 45056
    s_nop 0
    buffer_load_dwordx4 v121, s[16:19], s51 offen lds
    s_branch L_tib_done
L_tib_R:
    s_add_u32 s53, s49, 1
    s_and_b32 s53, s53, 7
    s_lshl_b32 s51, s53, 7
    s_add_u32 m0, s54, 65536
    s_add_u32 s51, s51, s55
    buffer_load_dwordx4 v64, s[4:7], s51 offen lds
    s_add_u32 m0, s54, 65536
    s_lshl3_add_u32 s53, s53, s46
    buffer_load_dwordx4 v65, s[4:7], s51 offen offset:1024 lds
    s_mul_i32 s52, s53, 24576
    s_add_u32 m0, s85, 40960
    s_add_u32 s51, s52, s83
    buffer_load_dwordx4 v66, s[8:11], s51 offen lds
    s_add_u32 m0, s85, 43008
    s_add_u32 s51, s52, s68
    buffer_load_dwordx4 v66, s[8:11], s51 offen lds
    s_add_u32 m0, s85, 45056
    s_add_u32 s51, s51, 128
    buffer_load_dwordx4 v66, s[8:11], s51 offen lds
L_tib_done:
    s_waitcnt vmcnt(5)
    v_dot2c_f32_bf16 v72, s58, v88
    v_dot2c_f32_bf16 v73, v88, v88
    v_dot2c_f32_bf16 v72, s58, v89
    v_dot2c_f32_bf16 v73, v89, v89
    v_dot2c_f32_bf16 v72, s58, v90
    v_dot2c_f32_bf16 v73, v90, v90
    v_dot2c_f32_bf16 v72, s58, v91
    v_dot2c_f32_bf16 v73, v91, v91
    v_readfirstlane_b32 s50, v92
    s_nop 1
    v_add_f32_dpp v72, v72, v72 row_ror:1 row_mask:0xf bank_mask:0xf
    v_add_f32_dpp v73, v73, v73 row_ror:1 row_mask:0xf bank_mask:0xf
    s_nop 0
    v_add_f32_dpp v72, v72, v72 row_ror:2 row_mask:0xf bank_mask:0xf
    v_add_f32_dpp v73, v73, v73 row_ror:2 row_mask:0xf bank_mask:0xf
    s_nop 0
    v_add_f32_dpp v72, v72, v72 row_ror:4 row_mask:0xf bank_mask:0xf
    v_add_f32_dpp v73, v73, v73 row_ror:4 row_mask:0xf bank_mask:0xf
    s_nop 0
    v_add_f32_dpp v72, v72, v72 row_ror:8 row_mask:0xf bank_mask:0xf
    v_add_f32_dpp v73, v73, v73 row_ror:8 row_mask:0xf bank_mask:0xf
    s_nop 0
    s_mul_i32 s50, s50, 1664525
    s_add_u32 s50, s50, 1013904223
    v_mov_b32 v74, v72
    v_mov_b32 v75, v73
    s_nop 1
    v_permlane16_swap_b32 v72, v74
    v_permlane16_swap_b32 v73, v75
    s_nop 0
    v_add_f32 v72, v72, v74
    v_add_f32 v73, v73, v75
    v_mov_b32 v74, v72
    v_mov_b32 v75, v73
    s_nop 1
    v_permlane32_swap_b32 v72, v74
    v_permlane32_swap_b32 v73, v75
    s_nop 0
    v_add_f32 v72, v72, v74
    v_add_f32 v73, v73, v75
    v_mul_f32 v72, 0x3b000000, v72
    v_mul_f32 v73, 0x3b000000, v73
    v_fma_f32 v73, -v72, v72, v73
    v_max_f32 v73, 0, v73
    v_cvt_pk_bf16_f32 v88, -v72, -v72
    v_cvt_pk_bf16_f32 v73, v73, v73
    v_lshlrev_b32 v73, 16, v73
    v_add_f32 v73, 0x3727c5ac, v73
    v_cvt_pk_bf16_f32 v73, v73, v73
    v_lshlrev_b32 v73, 16, v73
    v_sqrt_f32 v73, v73
    v_mov_b32 v91, s50
    v_cvt_pk_bf16_f32 v73, v73, v73
    v_lshlrev_b32 v73, 16, v73
    v_rcp_f32 v89, v73
    v_mul_f32 v90, v73, v73
    s_lshl_b32 s60, s94, 4
    s_add_u32 s60, s60, 21037056
    s_mov_b64 exec, 1
    buffer_store_dwordx4 v[88:91], off, s[32:35], s60 sc1
    s_mov_b64 exec, -1
    s_cmp_ge_u32 s41, 8
    s_cbranch_scc1 L_nopo_c
    v_mov_b32 v72, -1
    s_add_u32 s60, s88, 114688
    buffer_store_dwordx4 v[72:75], v6, s[32:35], s60 offen sc1
    buffer_store_dwordx4 v[72:75], v6, s[32:35], s60 offen offset:1024 sc1
L_nopo_c:
    s_barrier
    s_cmp_ge_u32 s41, 12
    s_cbranch_scc1 L_R
    ds_read_b64_tr_b16 v[96:97], v67 offset:0
    ds_read_b64_tr_b16 v[98:99], v67 offset:512
    ds_read_b64_tr_b16 v[100:101], v8 offset:2048
    ds_read_b64_tr_b16 v[102:103], v8 offset:2560
    ds_read_b64_tr_b16 v[104:105], v9 offset:2048
    ds_read_b64_tr_b16 v[106:107], v9 offset:2560
    ds_read_b64_tr_b16 v[108:109], v67 offset:6144
    ds_read_b64_tr_b16 v[110:111], v67 offset:6656
    ds_read_b64_tr_b16 v[112:113], v8 offset:8192
    ds_read_b64_tr_b16 v[114:115], v8 offset:8704
    ds_read_b64_tr_b16 v[116:117], v9 offset:8192
    ds_read_b64_tr_b16 v[118:119], v9 offset:8704
    s_cmp_lg_u32 s48, 1
    s_cbranch_scc1 L_off_P
    s_barrier
L_off_P:
    ds_read_b128 v[128:131], v68
    ds_read_b128 v[132:135], v69
    s_add_u32 s53, s49, 2
    s_and_b32 s53, s53, 7
    s_lshl_b32 s51, s53, 7
    s_add_u32 m0, s54, 106496
    s_add_u32 s51, s51, s55
    buffer_load_dwordx4 v64, s[4:7], s51 offen lds
    s_add_u32 m0, s54, 106496
    s_lshl3_add_u32 s53, s53, s46
    buffer_load_dwordx4 v65, s[4:7], s51 offen offset:1024 lds
    s_mul_i32 s52, s53, 24576
    s_add_u32 m0, s85, 81920
    s_add_u32 s51, s52, s83
    buffer_load_dwordx4 v66, s[8:11], s51 offen lds
    s_mul_i32 s52, s53, 28672
    s_add_u32 m0, s85, 83968
    s_add_u32 s51, s52, s68
    buffer_load_dwordx4 v120, s[12:15], s51 offen lds
    s_add_u32 m0, s85, 86016
    s_nop 0
    buffer_load_dwordx4 v121, s[16:19], s51 offen lds
    s_waitcnt lgkmcnt(0)
    s_barrier
    v_mfma_f32_4x4x4_16b_bf16 v[76:79], v[10:11], v[96:97], 0
    v_mfma_f32_4x4x4_16b_bf16 v[80:83], v[10:11], v[100:101], 0
    v_mfma_f32_4x4x4_16b_bf16 v[84:87], v[10:11], v[104:105], 0
    v_mfma_f32_4x4x4_16b_bf16 v[76:79], v[10:11], v[98:99], v[76:79]
    v_mfma_f32_4x4x4_16b_bf16 v[80:83], v[10:11], v[102:103], v[80:83]
    v_mfma_f32_4x4x4_16b_bf16 v[84:87], v[10:11], v[106:107], v[84:87]
    v_mfma_f32_4x4x4_16b_bf16 v[76:79], v[10:11], v[108:109], v[76:79]
    v_mfma_f32_4x4x4_16b_bf16 v[80:83], v[10:11], v[112:113], v[80:83]
    v_mfma_f32_4x4x4_16b_bf16 v[84:87], v[10:11], v[116:117], v[84:87]
    v_mfma_f32_4x4x4_16b_bf16 v[76:79], v[10:11], v[110:111], v[76:79]
    v_mfma_f32_4x4x4_16b_bf16 v[80:83], v[10:11], v[114:115], v[80:83]
    v_mfma_f32_4x4x4_16b_bf16 v[84:87], v[10:11], v[118:119], v[84:87]
    v_mfma_f32_32x32x16_bf16 v[16:31], v[96:99], v[128:131], 0
    ds_read_b64_tr_b16 v[96:97], v67 offset:12288
    ds_read_b64_tr_b16 v[98:99], v67 offset:12800
    v_mfma_f32_32x32x16_bf16 v[32:47], v[100:103], v[128:131], 0
    ds_read_b64_tr_b16 v[100:101], v8 offset:14336
    ds_read_b64_tr_b16 v[102:103], v8 offset:14848
    v_mfma_f32_32x32x16_bf16 v[48:63], v[104:107], v[128:131], 0
    ds_read_b64_tr_b16 v[104:105], v9 offset:14336
    ds_read_b64_tr_b16 v[106:107], v9 offset:14848
    v_mfma_f32_32x32x16_bf16 v[16:31], v[108:111], v[132:135], v[16:31]
    ds_read_b64_tr_b16 v[108:109], v67 offset:18432
    ds_read_b64_tr_b16 v[110:111], v67 offset:18944
    v_mfma_f32_32x32x16_bf16 v[32:47], v[112:115], v[132:135], v[32:47]
    ds_read_b64_tr_b16 v[112:113], v8 offset:20480
    ds_read_b64_tr_b16 v[114:115], v8 offset:20992
    s_waitcnt vmcnt(5)
    v_mfma_f32_32x32x16_bf16 v[48:63], v[116:119], v[132:135], v[48:63]
    s_barrier
    ds_read_b64_tr_b16 v[116:117], v9 offset:20480
    ds_read_b64_tr_b16 v[118:119], v9 offset:20992
    ds_read_b128 v[136:139], v70
    ds_read_b128 v[140:143], v71
    v_add_u32 v67, 0xa000, v67
    v_add_u32 v8, 0xa000, v8
    v_add_u32 v9, 0xa000, v9
    v_add_u32 v68, 0xa000, v68
    v_add_u32 v69, 0xa000, v69
    v_add_u32 v70, 0xa000, v70
    v_add_u32 v71, 0xa000, v71
    s_add_u32 s53, s49, 3
    s_and_b32 s53, s53, 7
    s_lshl_b32 s51, s53, 7
    s_add_u32 m0, s54, 147456
    s_add_u32 s51, s51, s55
    buffer_load_dwordx4 v64, s[4:7], s51 offen lds
    s_add_u32 m0, s54, 147456
    s_lshl3_add_u32 s53, s53, s46
    buffer_load_dwordx4 v65, s[4:7], s51 offen offset:1024 lds
    s_mul_i32 s52, s53, 24576
    s_add_u32 m0, s85, 122880
    s_add_u32 s51, s52, s83
    buffer_load_dwordx4 v66, s[8:11], s51 offen lds
    s_waitcnt lgkmcnt(0)
    s_barrier
    v_mfma_f32_4x4x4_16b_bf16 v[76:79], v[10:11], v[96:97], v[76:79]
    v_mfma_f32_4x4x4_16b_bf16 v[80:83], v[10:11], v[100:101], v[80:83]
    v_mfma_f32_4x4x4_16b_bf16 v[84:87], v[10:11], v[104:105], v[84:87]
    v_mfma_f32_4x4x4_16b_bf16 v[76:79], v[10:11], v[98:99], v[76:79]
    v_mfma_f32_4x4x4_16b_bf16 v[80:83], v[10:11], v[102:103], v[80:83]
    v_mfma_f32_4x4x4_16b_bf16 v[84:87], v[10:11], v[106:107], v[84:87]
    v_mfma_f32_4x4x4_16b_bf16 v[76:79], v[10:11], v[108:109], v[76:79]
    v_mfma_f32_4x4x4_16b_bf16 v[80:83], v[10:11], v[112:113], v[80:83]
    v_mfma_f32_4x4x4_16b_bf16 v[84:87], v[10:11], v[116:117], v[84:87]
    v_mfma_f32_4x4x4_16b_bf16 v[76:79], v[10:11], v[110:111], v[76:79]
    v_mfma_f32_4x4x4_16b_bf16 v[80:83], v[10:11], v[114:115], v[80:83]
    v_mfma_f32_4x4x4_16b_bf16 v[84:87], v[10:11], v[118:119], v[84:87]
    v_mfma_f32_32x32x16_bf16 v[16:31], v[96:99], v[136:139], v[16:31]
    ds_read_b64_tr_b16 v[96:97], v67 offset:0
    ds_read_b64_tr_b16 v[98:99], v67 offset:512
    v_mfma_f32_32x32x16_bf16 v[32:47], v[100:103], v[136:139], v[32:47]
    ds_read_b64_tr_b16 v[100:101], v8 offset:2048
    ds_read_b64_tr_b16 v[102:103], v8 offset:2560
    v_mfma_f32_32x32x16_bf16 v[48:63], v[104:107], v[136:139], v[48:63]
    ds_read_b64_tr_b16 v[104:105], v9 offset:2048
    ds_read_b64_tr_b16 v[106:107], v9 offset:2560
    v_mfma_f32_32x32x16_bf16 v[16:31], v[108:111], v[140:143], v[16:31]
    ds_read_b64_tr_b16 v[108:109], v67 offset:6144
    ds_read_b64_tr_b16 v[110:111], v67 offset:6656
    v_mfma_f32_32x32x16_bf16 v[32:47], v[112:115], v[140:143], v[32:47]
    ds_read_b64_tr_b16 v[112:113], v8 offset:8192
    ds_read_b64_tr_b16 v[114:115], v8 offset:8704
    v_mfma_f32_32x32x16_bf16 v[48:63], v[116:119], v[140:143], v[48:63]
    s_barrier
    ds_read_b64_tr_b16 v[116:117], v9 offset:8192
    ds_read_b64_tr_b16 v[118:119], v9 offset:8704
    ds_read_b128 v[144:147], v68
    ds_read_b128 v[148:151], v69
    s_cmp_lg_u32 s47, 0
    s_cbranch_scc1 L_cp1
    v_permlane32_swap_b32 v76, v77
    v_permlane32_swap_b32 v80, v81
    v_permlane32_swap_b32 v84, v85
    v_mov_b32 v91, s50
    v_add_f32 v88, v76, v77
    v_add_f32 v89, v80, v81
    v_add_f32 v90, v84, v85
    s_add_u32 s94, s92, 0
    s_mov_b32 exec_hi, 0
    buffer_store_dwordx4 v[88:91], v6, s[32:35], s94 offen sc1
    s_mov_b64 exec, -1
L_cp1:
    s_mul_i32 s52, s53, 28672
    s_add_u32 m0, s85, 124928
    s_add_u32 s51, s52, s68
    buffer_load_dwordx4 v120, s[12:15], s51 offen lds
    s_add_u32 m0, s85, 126976
    s_nop 0
    buffer_load_dwordx4 v121, s[16:19], s51 offen lds
    s_add_u32 s53, s49, 4
    s_and_b32 s53, s53, 7
    s_lshl_b32 s51, s53, 7
    s_add_u32 m0, s54, 24576
    s_add_u32 s51, s51, s55
    buffer_load_dwordx4 v64, s[4:7], s51 offen lds
    s_add_u32 m0, s54, 24576
    s_lshl3_add_u32 s53, s53, s46
    buffer_load_dwordx4 v65, s[4:7], s51 offen offset:1024 lds
    s_mul_i32 s52, s53, 24576
    s_add_u32 m0, s85, 0
    s_add_u32 s51, s52, s83
    buffer_load_dwordx4 v66, s[8:11], s51 offen lds
    s_waitcnt lgkmcnt(0)
    s_barrier
    v_mfma_f32_32x32x16_bf16 v[16:31], v[96:99], v[144:147], v[16:31]
    ds_read_b64_tr_b16 v[96:97], v67 offset:12288
    ds_read_b64_tr_b16 v[98:99], v67 offset:12800
    v_mfma_f32_32x32x16_bf16 v[32:47], v[100:103], v[144:147], v[32:47]
    ds_read_b64_tr_b16 v[100:101], v8 offset:14336
    ds_read_b64_tr_b16 v[102:103], v8 offset:14848
    v_mfma_f32_32x32x16_bf16 v[48:63], v[104:107], v[144:147], v[48:63]
    ds_read_b64_tr_b16 v[104:105], v9 offset:14336
    ds_read_b64_tr_b16 v[106:107], v9 offset:14848
    v_mfma_f32_32x32x16_bf16 v[16:31], v[108:111], v[148:151], v[16:31]
    ds_read_b64_tr_b16 v[108:109], v67 offset:18432
    ds_read_b64_tr_b16 v[110:111], v67 offset:18944
    v_mfma_f32_32x32x16_bf16 v[32:47], v[112:115], v[148:151], v[32:47]
    ds_read_b64_tr_b16 v[112:113], v8 offset:20480
    ds_read_b64_tr_b16 v[114:115], v8 offset:20992
    s_waitcnt vmcnt(8)
    v_mfma_f32_32x32x16_bf16 v[48:63], v[116:119], v[148:151], v[48:63]
    s_barrier
    ds_read_b64_tr_b16 v[116:117], v9 offset:20480
    ds_read_b64_tr_b16 v[118:119], v9 offset:20992
    ds_read_b128 v[152:155], v70
    ds_read_b128 v[156:159], v71
    v_add_u32 v67, 0xa000, v67
    v_add_u32 v8, 0xa000, v8
    v_add_u32 v9, 0xa000, v9
    v_add_u32 v68, 0xa000, v68
    v_add_u32 v69, 0xa000, v69
    v_add_u32 v70, 0xa000, v70
    v_add_u32 v71, 0xa000, v71
    s_mul_i32 s52, s53, 28672
    s_add_u32 m0, s85, 2048
    s_add_u32 s51, s52, s68
    buffer_load_dwordx4 v120, s[12:15], s51 offen lds
    s_add_u32 m0, s85, 4096
    s_nop 0
    buffer_load_dwordx4 v121, s[16:19], s51 offen lds
    s_waitcnt lgkmcnt(0)
    s_barrier
    v_mfma_f32_32x32x16_bf16 v[16:31], v[96:99], v[152:155], v[16:31]
    ds_read_b64_tr_b16 v[96:97], v67 offset:0
    ds_read_b64_tr_b16 v[98:99], v67 offset:512
    v_mfma_f32_32x32x16_bf16 v[32:47], v[100:103], v[152:155], v[32:47]
    ds_read_b64_tr_b16 v[100:101], v8 offset:2048
    ds_read_b64_tr_b16 v[102:103], v8 offset:2560
    v_mfma_f32_32x32x16_bf16 v[48:63], v[104:107], v[152:155], v[48:63]
    ds_read_b64_tr_b16 v[104:105], v9 offset:2048
    ds_read_b64_tr_b16 v[106:107], v9 offset:2560
    v_mfma_f32_32x32x16_bf16 v[16:31], v[108:111], v[156:159], v[16:31]
    ds_read_b64_tr_b16 v[108:109], v67 offset:6144
    ds_read_b64_tr_b16 v[110:111], v67 offset:6656
    v_mfma_f32_32x32x16_bf16 v[32:47], v[112:115], v[156:159], v[32:47]
    ds_read_b64_tr_b16 v[112:113], v8 offset:8192
    ds_read_b64_tr_b16 v[114:115], v8 offset:8704
    v_mfma_f32_32x32x16_bf16 v[48:63], v[116:119], v[156:159], v[48:63]
    s_barrier
    ds_read_b64_tr_b16 v[116:117], v9 offset:8192
    ds_read_b64_tr_b16 v[118:119], v9 offset:8704
    ds_read_b128 v[160:163], v68
    ds_read_b128 v[164:167], v69
    s_add_u32 s53, s49, 5
    s_and_b32 s53, s53, 7
    s_lshl_b32 s51, s53, 7
    s_add_u32 m0, s54, 65536
    s_add_u32 s51, s51, s55
    buffer_load_dwordx4 v64, s[4:7], s51 offen lds
    s_add_u32 m0, s54, 65536
    s_lshl3_add_u32 s53, s53, s46
    buffer_load_dwordx4 v65, s[4:7], s51 offen offset:1024 lds
    s_mul_i32 s52, s53, 24576
    s_add_u32 m0, s85, 40960
    s_add_u32 s51, s52, s83
    buffer_load_dwordx4 v66, s[8:11], s51 offen lds
    s_waitcnt lgkmcnt(0)
    s_barrier
    v_mfma_f32_32x32x16_bf16 v[16:31], v[96:99], v[160:163], v[16:31]
    ds_read_b64_tr_b16 v[96:97], v67 offset:12288
    ds_read_b64_tr_b16 v[98:99], v67 offset:12800
    v_mfma_f32_32x32x16_bf16 v[32:47], v[100:103], v[160:163], v[32:47]
    ds_read_b64_tr_b16 v[100:101], v8 offset:14336
    ds_read_b64_tr_b16 v[102:103], v8 offset:14848
    v_mfma_f32_32x32x16_bf16 v[48:63], v[104:107], v[160:163], v[48:63]
    ds_read_b64_tr_b16 v[104:105], v9 offset:14336
    ds_read_b64_tr_b16 v[106:107], v9 offset:14848
    v_mfma_f32_32x32x16_bf16 v[16:31], v[108:111], v[164:167], v[16:31]
    ds_read_b64_tr_b16 v[108:109], v67 offset:18432
    ds_read_b64_tr_b16 v[110:111], v67 offset:18944
    v_mfma_f32_32x32x16_bf16 v[32:47], v[112:115], v[164:167], v[32:47]
    ds_read_b64_tr_b16 v[112:113], v8 offset:20480
    ds_read_b64_tr_b16 v[114:115], v8 offset:20992
    s_waitcnt vmcnt(8)
    v_mfma_f32_32x32x16_bf16 v[48:63], v[116:119], v[164:167], v[48:63]
    s_barrier
    ds_read_b64_tr_b16 v[116:117], v9 offset:20480
    ds_read_b64_tr_b16 v[118:119], v9 offset:20992
    ds_read_b128 v[168:171], v70
    ds_read_b128 v[172:175], v71
    v_add_u32 v67, 0xa000, v67
    v_add_u32 v8, 0xa000, v8
    v_add_u32 v9, 0xa000, v9
    v_add_u32 v68, 0xa000, v68
    v_add_u32 v69, 0xa000, v69
    v_add_u32 v70, 0xa000, v70
    v_add_u32 v71, 0xa000, v71
    s_mul_i32 s52, s53, 28672
    s_add_u32 m0, s85, 43008
    s_add_u32 s51, s52, s68
    buffer_load_dwordx4 v120, s[12:15], s51 offen lds
    s_add_u32 m0, s85, 45056
    s_nop 0
    buffer_load_dwordx4 v121, s[16:19], s51 offen lds
    s_waitcnt lgkmcnt(0)
    s_barrier
    v_mfma_f32_32x32x16_bf16 v[16:31], v[96:99], v[168:171], v[16:31]
    ds_read_b64_tr_b16 v[96:97], v67 offset:0
    ds_read_b64_tr_b16 v[98:99], v67 offset:512
    v_mfma_f32_32x32x16_bf16 v[32:47], v[100:103], v[168:171], v[32:47]
    ds_read_b64_tr_b16 v[100:101], v8 offset:2048
    ds_read_b64_tr_b16 v[102:103], v8 offset:2560
    v_mfma_f32_32x32x16_bf16 v[48:63], v[104:107], v[168:171], v[48:63]
    ds_read_b64_tr_b16 v[104:105], v9 offset:2048
    ds_read_b64_tr_b16 v[106:107], v9 offset:2560
    v_mfma_f32_32x32x16_bf16 v[16:31], v[108:111], v[172:175], v[16:31]
    ds_read_b64_tr_b16 v[108:109], v67 offset:6144
    ds_read_b64_tr_b16 v[110:111], v67 offset:6656
    v_mfma_f32_32x32x16_bf16 v[32:47], v[112:115], v[172:175], v[32:47]
    ds_read_b64_tr_b16 v[112:113], v8 offset:8192
    ds_read_b64_tr_b16 v[114:115], v8 offset:8704
    v_mfma_f32_32x32x16_bf16 v[48:63], v[116:119], v[172:175], v[48:63]
    s_barrier
    ds_read_b64_tr_b16 v[116:117], v9 offset:8192
    ds_read_b64_tr_b16 v[118:119], v9 offset:8704
    ds_read_b128 v[176:179], v68
    ds_read_b128 v[180:183], v69
    s_add_u32 s53, s49, 6
    s_and_b32 s53, s53, 7
    s_lshl_b32 s51, s53, 7
    s_add_u32 m0, s54, 106496
    s_add_u32 s51, s51, s55
    buffer_load_dwordx4 v64, s[4:7], s51 offen lds
    s_add_u32 m0, s54, 106496
    s_lshl3_add_u32 s53, s53, s46
    buffer_load_dwordx4 v65, s[4:7], s51 offen offset:1024 lds
    s_mul_i32 s52, s53, 24576
    s_add_u32 m0, s85, 81920
    s_add_u32 s51, s52, s83
    buffer_load_dwordx4 v66, s[8:11], s51 offen lds
    s_waitcnt lgkmcnt(0)
    s_barrier
    v_mfma_f32_32x32x16_bf16 v[16:31], v[96:99], v[176:179], v[16:31]
    ds_read_b64_tr_b16 v[96:97], v67 offset:12288
    ds_read_b64_tr_b16 v[98:99], v67 offset:12800
    v_mfma_f32_32x32x16_bf16 v[32:47], v[100:103], v[176:179], v[32:47]
    ds_read_b64_tr_b16 v[100:101], v8 offset:14336
    ds_read_b64_tr_b16 v[102:103], v8 offset:14848
    v_mfma_f32_32x32x16_bf16 v[48:63], v[104:107], v[176:179], v[48:63]
    ds_read_b64_tr_b16 v[104:105], v9 offset:14336
    ds_read_b64_tr_b16 v[106:107], v9 offset:14848
    v_mfma_f32_32x32x16_bf16 v[16:31], v[108:111], v[180:183], v[16:31]
    ds_read_b64_tr_b16 v[108:109], v67 offset:18432
    ds_read_b64_tr_b16 v[110:111], v67 offset:18944
    v_mfma_f32_32x32x16_bf16 v[32:47], v[112:115], v[180:183], v[32:47]
    ds_read_b64_tr_b16 v[112:113], v8 offset:20480
    ds_read_b64_tr_b16 v[114:115], v8 offset:20992
    s_waitcnt vmcnt(8)
    v_mfma_f32_32x32x16_bf16 v[48:63], v[116:119], v[180:183], v[48:63]
    s_barrier
    ds_read_b64_tr_b16 v[116:117], v9 offset:20480
    ds_read_b64_tr_b16 v[118:119], v9 offset:20992
    ds_read_b128 v[184:187], v70
    ds_read_b128 v[188:191], v71
    v_add_u32 v67, 0xfffe2000, v67
    v_add_u32 v8, 0xfffe2000, v8
    v_add_u32 v9, 0xfffe2000, v9
    v_add_u32 v68, 0xfffe2000, v68
    v_add_u32 v69, 0xfffe2000, v69
    v_add_u32 v70, 0xfffe2000, v70
    v_add_u32 v71, 0xfffe2000, v71
    s_mul_i32 s52, s53, 28672
    s_add_u32 m0, s85, 83968
    s_add_u32 s51, s52, s68
    buffer_load_dwordx4 v120, s[12:15], s51 offen lds
    s_add_u32 m0, s85, 86016
    s_nop 0
    buffer_load_dwordx4 v121, s[16:19], s51 offen lds
    s_lshl_b32 s94, s59, 9
    s_add_u32 s94, s94, 21037056
    buffer_load_dwordx4 v[72:75], v94, s[32:35], s94 offen sc1
    s_waitcnt lgkmcnt(0)
    s_barrier
    v_mfma_f32_32x32x16_bf16 v[16:31], v[96:99], v[184:187], v[16:31]
    ds_read_b64_tr_b16 v[96:97], v67 offset:0
    ds_read_b64_tr_b16 v[98:99], v67 offset:512
    v_mfma_f32_32x32x16_bf16 v[32:47], v[100:103], v[184:187], v[32:47]
    ds_read_b64_tr_b16 v[100:101], v8 offset:2048
    ds_read_b64_tr_b16 v[102:103], v8 offset:2560
    v_mfma_f32_32x32x16_bf16 v[48:63], v[104:107], v[184:187], v[48:63]
    ds_read_b64_tr_b16 v[104:105], v9 offset:2048
    ds_read_b64_tr_b16 v[106:107], v9 offset:2560
    v_mfma_f32_32x32x16_bf16 v[16:31], v[108:111], v[188:191], v[16:31]
    ds_read_b64_tr_b16 v[108:109], v67 offset:6144
    ds_read_b64_tr_b16 v[110:111], v67 offset:6656
    v_mfma_f32_32x32x16_bf16 v[32:47], v[112:115], v[188:191], v[32:47]
    ds_read_b64_tr_b16 v[112:113], v8 offset:8192
    ds_read_b64_tr_b16 v[114:115], v8 offset:8704
    v_mfma_f32_32x32x16_bf16 v[48:63], v[116:119], v[188:191], v[48:63]
    s_barrier
    ds_read_b64_tr_b16 v[116:117], v9 offset:8192
    ds_read_b64_tr_b16 v[118:119], v9 offset:8704
    ds_read_b128 v[192:195], v68
    ds_read_b128 v[196:199], v69
    s_add_u32 s53, s49, 7
    s_and_b32 s53, s53, 7
    s_lshl_b32 s51, s53, 7
    s_add_u32 m0, s54, 147456
    s_add_u32 s51, s51, s55
    buffer_load_dwordx4 v64, s[4:7], s51 offen lds
    s_add_u32 m0, s54, 147456
    s_lshl3_add_u32 s53, s53, s46
    buffer_load_dwordx4 v65, s[4:7], s51 offen offset:1024 lds
    s_mul_i32 s52, s53, 24576
    s_add_u32 m0, s85, 122880
    s_add_u32 s51, s52, s83
    buffer_load_dwordx4 v66, s[8:11], s51 offen lds
    s_waitcnt lgkmcnt(0)
    s_barrier
    v_mfma_f32_32x32x16_bf16 v[16:31], v[96:99], v[192:195], v[16:31]
    ds_read_b64_tr_b16 v[96:97], v67 offset:12288
    ds_read_b64_tr_b16 v[98:99], v67 offset:12800
    v_mfma_f32_32x32x16_bf16 v[32:47], v[100:103], v[192:195], v[32:47]
    ds_read_b64_tr_b16 v[100:101], v8 offset:14336
    ds_read_b64_tr_b16 v[102:103], v8 offset:14848
    v_mfma_f32_32x32x16_bf16 v[48:63], v[104:107], v[192:195], v[48:63]
    ds_read_b64_tr_b16 v[104:105], v9 offset:14336
    ds_read_b64_tr_b16 v[106:107], v9 offset:14848
    v_mfma_f32_32x32x16_bf16 v[16:31], v[108:111], v[196:199], v[16:31]
    ds_read_b64_tr_b16 v[108:109], v67 offset:18432
    ds_read_b64_tr_b16 v[110:111], v67 offset:18944
    v_mfma_f32_32x32x16_bf16 v[32:47], v[112:115], v[196:199], v[32:47]
    ds_read_b64_tr_b16 v[112:113], v8 offset:20480
    ds_read_b64_tr_b16 v[114:115], v8 offset:20992
    s_waitcnt vmcnt(9)
    v_mfma_f32_32x32x16_bf16 v[48:63], v[116:119], v[196:199], v[48:63]
    s_barrier
    ds_read_b64_tr_b16 v[116:117], v9 offset:20480
    ds_read_b64_tr_b16 v[118:119], v9 offset:20992
    ds_read_b128 v[200:203], v70
    ds_read_b128 v[204:207], v71
    v_add_u32 v67, 0xa000, v67
    v_add_u32 v8, 0xa000, v8
    v_add_u32 v9, 0xa000, v9
    v_add_u32 v68, 0xa000, v68
    v_add_u32 v69, 0xa000, v69
    v_add_u32 v70, 0xa000, v70
    v_add_u32 v71, 0xa000, v71
    s_mul_i32 s52, s53, 28672
    s_add_u32 m0, s85, 124928
    s_add_u32 s51, s52, s68
    buffer_load_dwordx4 v120, s[12:15], s51 offen lds
    s_add_u32 m0, s85, 126976
    s_nop 0
    buffer_load_dwordx4 v121, s[16:19], s51 offen lds
    buffer_load_dwordx4 v[76:79], v6, s[32:35], s93 offen offset:0 sc1
    s_waitcnt lgkmcnt(0)
    s_barrier
    v_mfma_f32_32x32x16_bf16 v[16:31], v[96:99], v[200:203], v[16:31]
    ds_read_b64_tr_b16 v[96:97], v67 offset:0
    ds_read_b64_tr_b16 v[98:99], v67 offset:512
    v_mfma_f32_32x32x16_bf16 v[32:47], v[100:103], v[200:203], v[32:47]
    ds_read_b64_tr_b16 v[100:101], v8 offset:2048
    ds_read_b64_tr_b16 v[102:103], v8 offset:2560
    v_mfma_f32_32x32x16_bf16 v[48:63], v[104:107], v[200:203], v[48:63]
    ds_read_b64_tr_b16 v[104:105], v9 offset:2048
    ds_read_b64_tr_b16 v[106:107], v9 offset:2560
    v_mfma_f32_32x32x16_bf16 v[16:31], v[108:111], v[204:207], v[16:31]
    ds_read_b64_tr_b16 v[108:109], v67 offset:6144
    ds_read_b64_tr_b16 v[110:111], v67 offset:6656
    v_mfma_f32_32x32x16_bf16 v[32:47], v[112:115], v[204:207], v[32:47]
    ds_read_b64_tr_b16 v[112:113], v8 offset:8192
    ds_read_b64_tr_b16 v[114:115], v8 offset:8704
    v_mfma_f32_32x32x16_bf16 v[48:63], v[116:119], v[204:207], v[48:63]
    s_barrier
    ds_read_b64_tr_b16 v[116:117], v9 offset:8192
    ds_read_b64_tr_b16 v[118:119], v9 offset:8704
    ds_read_b128 v[208:211], v68
    ds_read_b128 v[212:215], v69
    s_add_u32 s53, s90, 0
    s_and_b32 s53, s53, 7
    s_lshl2_add_u32 s53, s53, s47
    s_mul_i32 s53, s53, 57344
    s_add_u32 s53, s53, s69
    s_add_u32 m0, s86, 0
    s_add_u32 s52, s53, 28672
    buffer_load_dwordx4 v120, s[12:15], s53 offen lds
    buffer_load_dwordx4 v[80:83], v6, s[32:35], s93 offen offset:1024 sc1
    s_waitcnt lgkmcnt(0)
    s_barrier
    v_mfma_f32_32x32x16_bf16 v[16:31], v[96:99], v[208:211], v[16:31]
    ds_read_b64_tr_b16 v[96:97], v67 offset:12288
    ds_read_b64_tr_b16 v[98:99], v67 offset:12800
    v_mfma_f32_32x32x16_bf16 v[32:47], v[100:103], v[208:211], v[32:47]
    ds_read_b64_tr_b16 v[100:101], v8 offset:14336
    ds_read_b64_tr_b16 v[102:103], v8 offset:14848
    v_mfma_f32_32x32x16_bf16 v[48:63], v[104:107], v[208:211], v[48:63]
    ds_read_b64_tr_b16 v[104:105], v9 offset:14336
    ds_read_b64_tr_b16 v[106:107], v9 offset:14848
    v_mfma_f32_32x32x16_bf16 v[16:31], v[108:111], v[212:215], v[16:31]
    ds_read_b64_tr_b16 v[108:109], v67 offset:18432
    ds_read_b64_tr_b16 v[110:111], v67 offset:18944
    v_mfma_f32_32x32x16_bf16 v[32:47], v[112:115], v[212:215], v[32:47]
    ds_read_b64_tr_b16 v[112:113], v8 offset:20480
    ds_read_b64_tr_b16 v[114:115], v8 offset:20992
    s_waitcnt vmcnt(9)
    v_mfma_f32_32x32x16_bf16 v[48:63], v[116:119], v[212:215], v[48:63]
    s_barrier
    ds_read_b64_tr_b16 v[116:117], v9 offset:20480
    ds_read_b64_tr_b16 v[118:119], v9 offset:20992
    ds_read_b128 v[216:219], v70
    ds_read_b128 v[220:223], v71
    v_add_u32 v67, 0xa000, v67
    v_add_u32 v8, 0xa000, v8
    v_add_u32 v9, 0xa000, v9
    v_add_u32 v68, 0xa000, v68
    v_add_u32 v69, 0xa000, v69
    v_add_u32 v70, 0xa000, v70
    v_add_u32 v71, 0xa000, v71
    s_add_u32 m0, s86, 1024
    s_nop 0
    buffer_load_dwordx4 v120, s[12:15], s52 offen lds
    buffer_load_dwordx4 v[84:87], v6, s[32:35], s93 offen offset:2048 sc1
    s_waitcnt lgkmcnt(0)
    s_barrier
    v_mfma_f32_32x32x16_bf16 v[16:31], v[96:99], v[216:219], v[16:31]
    ds_read_b64_tr_b16 v[96:97], v67 offset:0
    ds_read_b64_tr_b16 v[98:99], v67 offset:512
    v_mfma_f32_32x32x16_bf16 v[32:47], v[100:103], v[216:219], v[32:47]
    ds_read_b64_tr_b16 v[100:101], v8 offset:2048
    ds_read_b64_tr_b16 v[102:103], v8 offset:2560
    v_mfma_f32_32x32x16_bf16 v[48:63], v[104:107], v[216:219], v[48:63]
    ds_read_b64_tr_b16 v[104:105], v9 offset:2048
    ds_read_b64_tr_b16 v[106:107], v9 offset:2560
    v_mfma_f32_32x32x16_bf16 v[16:31], v[108:111], v[220:223], v[16:31]
    ds_read_b64_tr_b16 v[108:109], v67 offset:6144
    ds_read_b64_tr_b16 v[110:111], v67 offset:6656
    v_mfma_f32_32x32x16_bf16 v[32:47], v[112:115], v[220:223], v[32:47]
    ds_read_b64_tr_b16 v[112:113], v8 offset:8192
    ds_read_b64_tr_b16 v[114:115], v8 offset:8704
    v_mfma_f32_32x32x16_bf16 v[48:63], v[116:119], v[220:223], v[48:63]
    s_barrier
    ds_read_b64_tr_b16 v[116:117], v9 offset:8192
    ds_read_b64_tr_b16 v[118:119], v9 offset:8704
    ds_read_b128 v[224:227], v68
    ds_read_b128 v[228:231], v69
    s_add_u32 m0, s86, 2048
    s_nop 0
    buffer_load_dwordx4 v121, s[16:19], s53 offen lds
    buffer_load_dwordx4 v[88:91], v6, s[32:35], s93 offen offset:3072 sc1
    s_waitcnt lgkmcnt(0)
    s_barrier
    v_mfma_f32_32x32x16_bf16 v[16:31], v[96:99], v[224:227], v[16:31]
    ds_read_b64_tr_b16 v[96:97], v67 offset:12288
    ds_read_b64_tr_b16 v[98:99], v67 offset:12800
    v_mfma_f32_32x32x16_bf16 v[32:47], v[100:103], v[224:227], v[32:47]
    ds_read_b64_tr_b16 v[100:101], v8 offset:14336
    ds_read_b64_tr_b16 v[102:103], v8 offset:14848
    v_mfma_f32_32x32x16_bf16 v[48:63], v[104:107], v[224:227], v[48:63]
    ds_read_b64_tr_b16 v[104:105], v9 offset:14336
    ds_read_b64_tr_b16 v[106:107], v9 offset:14848
    v_mfma_f32_32x32x16_bf16 v[16:31], v[108:111], v[228:231], v[16:31]
    ds_read_b64_tr_b16 v[108:109], v67 offset:18432
    ds_read_b64_tr_b16 v[110:111], v67 offset:18944
    v_mfma_f32_32x32x16_bf16 v[32:47], v[112:115], v[228:231], v[32:47]
    ds_read_b64_tr_b16 v[112:113], v8 offset:20480
    ds_read_b64_tr_b16 v[114:115], v8 offset:20992
    s_waitcnt vmcnt(7)
    v_mfma_f32_32x32x16_bf16 v[48:63], v[116:119], v[228:231], v[48:63]
    s_barrier
    ds_read_b64_tr_b16 v[116:117], v9 offset:20480
    ds_read_b64_tr_b16 v[118:119], v9 offset:20992
    ds_read_b128 v[232:235], v70
    ds_read_b128 v[236:239], v71
    v_add_u32 v67, 0xa000, v67
    v_add_u32 v8, 0xa000, v8
    v_add_u32 v9, 0xa000, v9
    v_add_u32 v68, 0xa000, v68
    v_add_u32 v69, 0xa000, v69
    v_add_u32 v70, 0xa000, v70
    v_add_u32 v71, 0xa000, v71
    s_add_u32 m0, s86, 3072
    s_nop 0
    buffer_load_dwordx4 v121, s[16:19], s52 offen lds
    s_waitcnt lgkmcnt(0)
    s_barrier
    v_mfma_f32_32x32x16_bf16 v[16:31], v[96:99], v[232:235], v[16:31]
    ds_read_b64_tr_b16 v[96:97], v67 offset:0
    ds_read_b64_tr_b16 v[98:99], v67 offset:512
    v_mfma_f32_32x32x16_bf16 v[32:47], v[100:103], v[232:235], v[32:47]
    ds_read_b64_tr_b16 v[100:101], v8 offset:2048
    ds_read_b64_tr_b16 v[102:103], v8 offset:2560
    v_mfma_f32_32x32x16_bf16 v[48:63], v[104:107], v[232:235], v[48:63]
    ds_read_b64_tr_b16 v[104:105], v9 offset:2048
    ds_read_b64_tr_b16 v[106:107], v9 offset:2560
    v_mfma_f32_32x32x16_bf16 v[16:31], v[108:111], v[236:239], v[16:31]
    ds_read_b64_tr_b16 v[108:109], v67 offset:6144
    ds_read_b64_tr_b16 v[110:111], v67 offset:6656
    v_mfma_f32_32x32x16_bf16 v[32:47], v[112:115], v[236:239], v[32:47]
    ds_read_b64_tr_b16 v[112:113], v8 offset:8192
    ds_read_b64_tr_b16 v[114:115], v8 offset:8704
    v_mfma_f32_32x32x16_bf16 v[48:63], v[116:119], v[236:239], v[48:63]
    s_barrier
    ds_read_b64_tr_b16 v[116:117], v9 offset:8192
    ds_read_b64_tr_b16 v[118:119], v9 offset:8704
    ds_read_b128 v[240:243], v68
    ds_read_b128 v[244:247], v69
    s_add_u32 s53, s90, 2
    s_and_b32 s53, s53, 7
    s_lshl2_add_u32 s53, s53, s47
    s_mul_i32 s53, s53, 57344
    s_add_u32 s53, s53, s69
    s_add_u32 m0, s86, 40960
    s_add_u32 s52, s53, 28672
    buffer_load_dwordx4 v120, s[12:15], s53 offen lds
    s_add_u32 m0, s86, 41984
    s_nop 0
    buffer_load_dwordx4 v120, s[12:15], s52 offen lds
    s_waitcnt vmcnt(3)
L_gr_P_chk:
    v_min3_u32 v92, v75, v79, v83
    v_max3_u32 v95, v75, v79, v83
    v_min3_u32 v92, v92, v87, v91
    v_max3_u32 v95, v95, v87, v91
    v_xor_b32 v92, s50, v92
    v_xor_b32 v95, s50, v95
    v_or_b32 v92, v92, v95
    v_cmp_ne_u32 vcc, 0, v92
    s_cmp_eq_u32 s66, 0
    s_cbranch_scc1 L_gr_P_ok
    s_nop 0
    s_cbranch_vccz L_gr_P_ok
    s_sub_u32 s66, s66, 1
    s_sleep 1
    buffer_load_dwordx4 v[72:75], v94, s[32:35], s94 offen sc1
    buffer_load_dwordx4 v[76:79], v6, s[32:35], s93 offen offset:0 sc1
    buffer_load_dwordx4 v[80:83], v6, s[32:35], s93 offen offset:1024 sc1
    buffer_load_dwordx4 v[84:87], v6, s[32:35], s93 offen offset:2048 sc1
    buffer_load_dwordx4 v[88:91], v6, s[32:35], s93 offen offset:3072 sc1
    s_waitcnt vmcnt(0)
    s_branch L_gr_P_chk
L_gr_P_ok:
    v_mul_f32 v0, 0xbfb8aa3b, v73
    v_mov_b32 v126, v74
    v_mov_b32 v7, v72
    s_waitcnt lgkmcnt(0)
    s_barrier
    v_mfma_f32_32x32x16_bf16 v[16:31], v[96:99], v[240:243], v[16:31]
    ds_read_b64_tr_b16 v[96:97], v67 offset:12288
    ds_read_b64_tr_b16 v[98:99], v67 offset:12800
    v_add_f32 v76, v76, v80
    v_add_f32 v84, v84, v88
    v_add_f32 v77, v77, v81
    v_mfma_f32_32x32x16_bf16 v[32:47], v[100:103], v[240:243], v[32:47]
    ds_read_b64_tr_b16 v[100:101], v8 offset:14336
    ds_read_b64_tr_b16 v[102:103], v8 offset:14848
    v_add_f32 v85, v85, v89
    v_add_f32 v78, v78, v82
    v_add_f32 v86, v86, v90
    v_mfma_f32_32x32x16_bf16 v[48:63], v[104:107], v[240:243], v[48:63]
    ds_read_b64_tr_b16 v[104:105], v9 offset:14336
    ds_read_b64_tr_b16 v[106:107], v9 offset:14848
    v_add_f32 v76, v76, v84
    v_add_f32 v77, v77, v85
    v_add_f32 v78, v78, v86
    v_mfma_f32_32x32x16_bf16 v[16:31], v[108:111], v[244:247], v[16:31]
    ds_read_b64_tr_b16 v[108:109], v67 offset:18432
    ds_read_b64_tr_b16 v[110:111], v67 offset:18944
    v_cvt_pk_bf16_f32 v80, v76, v76
    v_cvt_pk_bf16_f32 v81, v77, v77
    v_cvt_pk_bf16_f32 v82, v78, v78
    v_mfma_f32_32x32x16_bf16 v[32:47], v[112:115], v[244:247], v[32:47]
    ds_read_b64_tr_b16 v[112:113], v8 offset:20480
    ds_read_b64_tr_b16 v[114:115], v8 offset:20992
    v_lshlrev_b32 v80, 16, v80
    v_lshlrev_b32 v81, 16, v81
    v_lshlrev_b32 v82, 16, v82
    s_waitcnt vmcnt(2)
    v_mfma_f32_32x32x16_bf16 v[48:63], v[116:119], v[244:247], v[48:63]
    s_barrier
    ds_read_b64_tr_b16 v[116:117], v9 offset:20480
    ds_read_b64_tr_b16 v[118:119], v9 offset:20992
    ds_read_b128 v[248:251], v70
    ds_read_b128 v[252:255], v71
    v_add_u32 v8, 0xfffe2000, v8
    v_add_u32 v9, 0xfffe2000, v9
    s_add_u32 m0, s86, 43008
    s_nop 0
    buffer_load_dwordx4 v121, s[16:19], s53 offen lds
    s_add_u32 m0, s86, 44032
    s_nop 0
    buffer_load_dwordx4 v121, s[16:19], s52 offen lds
    v_sub_f32 v80, v76, v80
    v_sub_f32 v81, v77, v81
    v_sub_f32 v82, v78, v82
    v_cvt_pk_bf16_f32 v76, v76, v80
    v_cvt_pk_bf16_f32 v77, v77, v81
    v_cvt_pk_bf16_f32 v78, v78, v82
    v_mov_b32 v79, 0
    v_mov_b32 v80, 0
    v_mov_b32 v81, 0
    v_mov_b32 v82, v7
    v_mov_b32 v83, 0
    v_mov_b32 v84, 0
    v_mov_b32 v85, 0
    v_mov_b32 v86, 0
    v_mov_b32 v87, v7
    v_mov_b32 v88, 0
    v_mov_b32 v89, 0
    s_waitcnt lgkmcnt(0)
    s_barrier
    v_mfma_f32_32x32x16_bf16 v[16:31], v[76:79], v[82:85], v[16:31]
    v_mfma_f32_32x32x16_bf16 v[32:47], v[76:79], v[86:89], v[32:47]
    v_mfma_f32_32x32x16_bf16 v[48:63], v[76:79], v[80:83], v[48:63]
    v_mfma_f32_32x32x16_bf16 v[16:31], v[96:99], v[248:251], v[16:31]
    ds_read_b64_tr_b16 v[96:97], v8 offset:0
    ds_read_b64_tr_b16 v[98:99], v8 offset:512
    v_mfma_f32_32x32x16_bf16 v[32:47], v[100:103], v[248:251], v[32:47]
    ds_read_b64_tr_b16 v[100:101], v9 offset:0
    ds_read_b64_tr_b16 v[102:103], v9 offset:512
    v_mfma_f32_32x32x16_bf16 v[48:63], v[104:107], v[248:251], v[48:63]
    ds_read_b64_tr_b16 v[104:105], v8 offset:4096
    ds_read_b64_tr_b16 v[106:107], v8 offset:4608
    v_mfma_f32_32x32x16_bf16 v[16:31], v[108:111], v[252:255], v[16:31]
    ds_read_b64_tr_b16 v[108:109], v9 offset:4096
    ds_read_b64_tr_b16 v[110:111], v9 offset:4608
    v_mfma_f32_32x32x16_bf16 v[32:47], v[112:115], v[252:255], v[32:47]
    ds_read_b64_tr_b16 v[112:113], v8 offset:8192
    ds_read_b64_tr_b16 v[114:115], v8 offset:8704
    v_mfma_f32_32x32x16_bf16 v[48:63], v[116:119], v[252:255], v[48:63]
    s_barrier
    ds_read_b64_tr_b16 v[116:117], v9 offset:8192
    ds_read_b64_tr_b16 v[118:119], v9 offset:8704
    s_add_u32 s53, s90, 4
    s_and_b32 s53, s53, 7
    s_lshl2_add_u32 s53, s53, s47
    s_mul_i32 s53, s53, 57344
    s_add_u32 s53, s53, s69
    s_add_u32 m0, s86, 81920
    s_add_u32 s52, s53, 28672
    buffer_load_dwordx4 v120, s[12:15], s53 offen lds
    v_mul_f32 v3, s87, v0
    s_nop 3
    v_mul_f32 v16, v3, v16
    v_mul_f32 v17, v3, v17
    v_mul_f32 v18, v3, v18
    v_mul_f32 v19, v3, v19
    v_mul_f32 v20, v3, v20
    v_mul_f32 v21, v3, v21
    v_mul_f32 v22, v3, v22
    v_mul_f32 v23, v3, v23
    v_mul_f32 v24, v3, v24
    v_mul_f32 v25, v3, v25
    v_mul_f32 v26, v3, v26
    v_mul_f32 v27, v3, v27
    v_mul_f32 v28, v3, v28
    v_mul_f32 v29, v3, v29
    s_add_u32 m0, s86, 82944
    s_nop 0
    buffer_load_dwordx4 v120, s[12:15], s52 offen lds
    v_mul_f32 v30, v3, v30
    v_mul_f32 v31, v3, v31
    v_cvt_pk_bf16_f32 v16, v16, v17
    v_cvt_pk_bf16_f32 v17, v18, v19
    v_cvt_pk_bf16_f32 v18, v20, v21
    v_cvt_pk_bf16_f32 v19, v22, v23
    v_cvt_pk_bf16_f32 v20, v24, v25
    v_cvt_pk_bf16_f32 v21, v26, v27
    v_cvt_pk_bf16_f32 v22, v28, v29
    v_cvt_pk_bf16_f32 v23, v30, v31
    buffer_store_dwordx4 v[16:19], v6, s[32:35], s64 offen sc1
    s_waitcnt lgkmcnt(0)
    s_barrier
    v_mfma_f32_4x4x4_16b_bf16 v[12:15], v[10:11], v[96:97], 0
    v_mfma_f32_4x4x4_16b_bf16 v[122:125], v[10:11], v[100:101], 0
    s_nop 0
    v_mfma_f32_4x4x4_16b_bf16 v[12:15], v[10:11], v[98:99], v[12:15]
    v_mfma_f32_4x4x4_16b_bf16 v[122:125], v[10:11], v[102:103], v[122:125]
    s_nop 0
    v_mfma_f32_4x4x4_16b_bf16 v[12:15], v[10:11], v[104:105], v[12:15]
    v_mfma_f32_4x4x4_16b_bf16 v[122:125], v[10:11], v[108:109], v[122:125]
    s_nop 0
    v_mfma_f32_4x4x4_16b_bf16 v[12:15], v[10:11], v[106:107], v[12:15]
    v_mfma_f32_4x4x4_16b_bf16 v[122:125], v[10:11], v[110:111], v[122:125]
    s_nop 0
    v_mfma_f32_4x4x4_16b_bf16 v[12:15], v[10:11], v[112:113], v[12:15]
    v_mfma_f32_4x4x4_16b_bf16 v[122:125], v[10:11], v[116:117], v[122:125]
    s_nop 0
    v_mfma_f32_4x4x4_16b_bf16 v[12:15], v[10:11], v[114:115], v[12:15]
    v_mfma_f32_4x4x4_16b_bf16 v[122:125], v[10:11], v[118:119], v[122:125]
    s_nop 0
    v_mfma_f32_32x32x16_bf16 v[64:79], v[96:99], v[128:131], 0
    ds_read_b64_tr_b16 v[96:97], v8 offset:12288
    ds_read_b64_tr_b16 v[98:99], v8 offset:12800
    v_mfma_f32_32x32x16_bf16 v[80:95], v[100:103], v[128:131], 0
    ds_read_b64_tr_b16 v[100:101], v9 offset:12288
    ds_read_b64_tr_b16 v[102:103], v9 offset:12800
    v_mfma_f32_32x32x16_bf16 v[64:79], v[104:107], v[132:135], v[64:79]
    ds_read_b64_tr_b16 v[104:105], v8 offset:16384
    ds_read_b64_tr_b16 v[106:107], v8 offset:16896
    v_mfma_f32_32x32x16_bf16 v[80:95], v[108:111], v[132:135], v[80:95]
    ds_read_b64_tr_b16 v[108:109], v9 offset:16384
    ds_read_b64_tr_b16 v[110:111], v9 offset:16896
    v_mfma_f32_32x32x16_bf16 v[64:79], v[112:115], v[136:139], v[64:79]
    ds_read_b64_tr_b16 v[112:113], v8 offset:20480
    ds_read_b64_tr_b16 v[114:115], v8 offset:20992
    s_waitcnt vmcnt(3)
    v_mfma_f32_32x32x16_bf16 v[80:95], v[116:119], v[136:139], v[80:95]
    s_barrier
    ds_read_b64_tr_b16 v[116:117], v9 offset:20480
    ds_read_b64_tr_b16 v[118:119], v9 offset:20992
    s_add_u32 s64, s64, 65536
    buffer_store_dwordx4 v[20:23], v6, s[32:35], s64 offen sc1
    v_mul_f32 v128, v0, v32
    v_mul_f32 v129, v0, v33
    v_mul_f32 v130, v0, v34
    v_mul_f32 v131, v0, v35
    v_mul_f32 v132, v0, v36
    v_mul_f32 v133, v0, v37
    v_mul_f32 v134, v0, v38
    v_mul_f32 v135, v0, v39
    v_exp_f32 v128, v128
    s_add_u32 m0, s86, 83968
    s_nop 0
    buffer_load_dwordx4 v121, s[16:19], s53 offen lds
    v_exp_f32 v129, v129
    v_exp_f32 v130, v130
    v_exp_f32 v131, v131
    v_exp_f32 v132, v132
    v_exp_f32 v133, v133
    s_waitcnt lgkmcnt(0)
    s_barrier
    v_mfma_f32_4x4x4_16b_bf16 v[12:15], v[10:11], v[96:97], v[12:15]
    v_mfma_f32_4x4x4_16b_bf16 v[122:125], v[10:11], v[100:101], v[122:125]
    s_nop 0
    v_mfma_f32_4x4x4_16b_bf16 v[12:15], v[10:11], v[98:99], v[12:15]
    v_mfma_f32_4x4x4_16b_bf16 v[122:125], v[10:11], v[102:103], v[122:125]
    s_nop 0
    v_mfma_f32_32x32x16_bf16 v[64:79], v[96:99], v[140:143], v[64:79]
    ds_read_b64_tr_b16 v[96:97], v8 offset:24576
    ds_read_b64_tr_b16 v[98:99], v8 offset:25088
    v_exp_f32 v134, v134
    v_exp_f32 v135, v135
    v_mfma_f32_32x32x16_bf16 v[80:95], v[100:103], v[140:143], v[80:95]
    ds_read_b64_tr_b16 v[100:101], v9 offset:24576
    ds_read_b64_tr_b16 v[102:103], v9 offset:25088
    v_mul_f32 v32, v32, v40
    v_mul_f32 v33, v33, v41
    v_mul_f32 v34, v34, v42
    v_mfma_f32_32x32x16_bf16 v[64:79], v[104:107], v[144:147], v[64:79]
    ds_read_b64_tr_b16 v[104:105], v8 offset:28672
    ds_read_b64_tr_b16 v[106:107], v8 offset:29184
    v_mul_f32 v35, v35, v43
    v_mul_f32 v36, v36, v44
    v_mul_f32 v37, v37, v45
    v_mfma_f32_32x32x16_bf16 v[80:95], v[108:111], v[144:147], v[80:95]
    ds_read_b64_tr_b16 v[108:109], v9 offset:28672
    ds_read_b64_tr_b16 v[110:111], v9 offset:29184
    v_mul_f32 v38, v38, v46
    v_mul_f32 v39, v39, v47
    v_fma_f32 v128, v128, v126, v126
    v_mfma_f32_32x32x16_bf16 v[64:79], v[112:115], v[148:151], v[64:79]
    ds_read_b64_tr_b16 v[112:113], v8 offset:40960
    ds_read_b64_tr_b16 v[114:115], v8 offset:41472
    v_fma_f32 v129, v129, v126, v126
    v_fma_f32 v130, v130, v126, v126
    v_fma_f32 v131, v131, v126, v126
    v_mfma_f32_32x32x16_bf16 v[80:95], v[116:119], v[148:151], v[80:95]
    s_barrier
    ds_read_b64_tr_b16 v[116:117], v9 offset:40960
    ds_read_b64_tr_b16 v[118:119], v9 offset:41472
    s_cmp_lg_u32 s47, 0
    s_cbranch_scc1 L_cp2
    v_permlane32_swap_b32 v12, v13
    v_permlane32_swap_b32 v122, v123
    v_mov_b32 v143, s50
    v_add_f32 v140, v12, v13
    v_add_f32 v141, v122, v123
    s_add_u32 s94, s92, 262144
    s_mov_b32 exec_hi, 0
    buffer_store_dwordx4 v[140:143], v6, s[32:35], s94 offen sc1
    s_mov_b64 exec, -1
L_cp2:
    s_add_u32 s93, s93, 262144
    v_mov_b32 v124, s50
    v_lshlrev_b32 v125, 3, v6
    v_add_u32 v122, s84, v6
    v_add_u32 v123, 7168, v4
    v_add_u32 v8, 0xa000, v8
    v_add_u32 v9, 0xa000, v9
    s_add_u32 m0, s86, 84992
    s_nop 0
    buffer_load_dwordx4 v121, s[16:19], s52 offen lds
    v_fma_f32 v132, v132, v126, v126
    v_fma_f32 v133, v133, v126, v126
    v_fma_f32 v134, v134, v126, v126
    v_fma_f32 v135, v135, v126, v126
    v_rcp_f32 v128, v128
    v_rcp_f32 v129, v129
    v_rcp_f32 v130, v130
    v_rcp_f32 v131, v131
    v_rcp_f32 v132, v132
    v_rcp_f32 v133, v133
    v_rcp_f32 v134, v134
    v_rcp_f32 v135, v135
    s_waitcnt lgkmcnt(0)
    s_barrier
    v_mfma_f32_32x32x16_bf16 v[64:79], v[96:99], v[152:155], v[64:79]
    ds_read_b64_tr_b16 v[96:97], v8 offset:4096
    ds_read_b64_tr_b16 v[98:99], v8 offset:4608
    v_mul_f32 v32, v32, v128
    v_mul_f32 v33, v33, v129
    v_mul_f32 v34, v34, v130
    v_mfma_f32_32x32x16_bf16 v[80:95], v[100:103], v[152:155], v[80:95]
    ds_read_b64_tr_b16 v[100:101], v9 offset:4096
    ds_read_b64_tr_b16 v[102:103], v9 offset:4608
    v_mul_f32 v35, v35, v131
    v_mul_f32 v36, v36, v132
    v_mul_f32 v37, v37, v133
    v_mfma_f32_32x32x16_bf16 v[64:79], v[104:107], v[156:159], v[64:79]
    ds_read_b64_tr_b16 v[104:105], v8 offset:8192
    ds_read_b64_tr_b16 v[106:107], v8 offset:8704
    v_mul_f32 v38, v38, v134
    v_mul_f32 v39, v39, v135
    v_cvt_pk_bf16_f32 v40, v32, v33
    v_mfma_f32_32x32x16_bf16 v[80:95], v[108:111], v[156:159], v[80:95]
    ds_read_b64_tr_b16 v[108:109], v9 offset:8192
    ds_read_b64_tr_b16 v[110:111], v9 offset:8704
    v_cvt_pk_bf16_f32 v41, v34, v35
    v_cvt_pk_bf16_f32 v42, v36, v37
    v_cvt_pk_bf16_f32 v43, v38, v39
    v_mfma_f32_32x32x16_bf16 v[64:79], v[112:115], v[160:163], v[64:79]
    ds_read_b64_tr_b16 v[112:113], v8 offset:12288
    ds_read_b64_tr_b16 v[114:115], v8 offset:12800
    v_mul_f32 v128, v0, v48
    v_mul_f32 v129, v0, v49
    v_mul_f32 v130, v0, v50
    v_mfma_f32_32x32x16_bf16 v[80:95], v[116:119], v[160:163], v[80:95]
    s_barrier
    ds_read_b64_tr_b16 v[116:117], v9 offset:12288
    ds_read_b64_tr_b16 v[118:119], v9 offset:12800
    buffer_store_dwordx4 v[40:43], v6, s[32:35], s88 offen offset:0 sc1
    v_mul_f32 v131, v0, v51
    v_mul_f32 v132, v0, v52
    v_mul_f32 v133, v0, v53
    v_mul_f32 v134, v0, v54
    v_mul_f32 v135, v0, v55
    v_exp_f32 v128, v128
    v_exp_f32 v129, v129
    v_exp_f32 v130, v130
    s_add_u32 s53, s90, 6
    s_and_b32 s53, s53, 7
    s_lshl2_add_u32 s53, s53, s47
    s_mul_i32 s53, s53, 57344
    s_add_u32 s53, s53, s69
    s_add_u32 m0, s86, 122880
    s_add_u32 s52, s53, 28672
    buffer_load_dwordx4 v120, s[12:15], s53 offen lds
    v_exp_f32 v131, v131
    v_exp_f32 v132, v132
    v_exp_f32 v133, v133
    v_exp_f32 v134, v134
    v_exp_f32 v135, v135
    s_waitcnt vmcnt(4)
    s_waitcnt lgkmcnt(0)
    s_barrier
    v_mfma_f32_32x32x16_bf16 v[64:79], v[96:99], v[164:167], v[64:79]
    ds_read_b64_tr_b16 v[96:97], v8 offset:16384
    ds_read_b64_tr_b16 v[98:99], v8 offset:16896
    v_mul_f32 v48, v48, v56
    v_mul_f32 v49, v49, v57
    v_mul_f32 v50, v50, v58
    v_mfma_f32_32x32x16_bf16 v[80:95], v[100:103], v[164:167], v[80:95]
    ds_read_b64_tr_b16 v[100:101], v9 offset:16384
    ds_read_b64_tr_b16 v[102:103], v9 offset:16896
    v_mul_f32 v51, v51, v59
    v_mul_f32 v52, v52, v60
    v_mul_f32 v53, v53, v61
    v_mfma_f32_32x32x16_bf16 v[64:79], v[104:107], v[168:171], v[64:79]
    ds_read_b64_tr_b16 v[104:105], v8 offset:20480
    ds_read_b64_tr_b16 v[106:107], v8 offset:20992
    v_mul_f32 v54, v54, v62
    v_mul_f32 v55, v55, v63
    v_fma_f32 v128, v128, v126, v126
    v_mfma_f32_32x32x16_bf16 v[80:95], v[108:111], v[168:171], v[80:95]
    ds_read_b64_tr_b16 v[108:109], v9 offset:20480
    ds_read_b64_tr_b16 v[110:111], v9 offset:20992
    v_fma_f32 v129, v129, v126, v126
    v_fma_f32 v130, v130, v126, v126
    v_fma_f32 v131, v131, v126, v126
    v_mfma_f32_32x32x16_bf16 v[64:79], v[112:115], v[172:175], v[64:79]
    ds_read_b64_tr_b16 v[112:113], v8 offset:24576
    ds_read_b64_tr_b16 v[114:115], v8 offset:25088
    v_fma_f32 v132, v132, v126, v126
    v_fma_f32 v133, v133, v126, v126
    v_fma_f32 v134, v134, v126, v126
    s_waitcnt vmcnt(2)
    v_mfma_f32_32x32x16_bf16 v[80:95], v[116:119], v[172:175], v[80:95]
    s_barrier
    ds_read_b64_tr_b16 v[116:117], v9 offset:24576
    ds_read_b64_tr_b16 v[118:119], v9 offset:25088
    s_cmp_lg_u32 s46, 0
    s_cbranch_scc1 L_fl3
    s_lshl4_add_u32 s94, s41, s40
    s_lshl_b32 s94, s94, 7
    s_add_u32 s94, s94, 20971520
    s_mov_b64 exec, 1
    buffer_store_dword v124, off, s[32:35], s94 sc1
    s_mov_b64 exec, -1
L_fl3:
    s_add_u32 m0, s86, 123904
    s_nop 0
    buffer_load_dwordx4 v120, s[12:15], s52 offen lds
    v_fma_f32 v135, v135, v126, v126
    v_rcp_f32 v128, v128
    v_rcp_f32 v129, v129
    v_rcp_f32 v130, v130
    v_rcp_f32 v131, v131
    v_rcp_f32 v132, v132
    s_add_u32 m0, s86, 124928
    s_nop 0
    buffer_load_dwordx4 v121, s[16:19], s53 offen lds
    v_rcp_f32 v133, v133
    v_rcp_f32 v134, v134
    v_rcp_f32 v135, v135
    v_mul_f32 v48, v48, v128
    v_mul_f32 v49, v49, v129
    v_mul_f32 v50, v50, v130
    v_mul_f32 v51, v51, v131
    s_waitcnt lgkmcnt(0)
    s_barrier
    v_mfma_f32_32x32x16_bf16 v[64:79], v[96:99], v[176:179], v[64:79]
    ds_read_b64_tr_b16 v[96:97], v8 offset:28672
    ds_read_b64_tr_b16 v[98:99], v8 offset:29184
    v_mul_f32 v52, v52, v132
    v_mul_f32 v53, v53, v133
    v_mul_f32 v54, v54, v134
    v_mfma_f32_32x32x16_bf16 v[80:95], v[100:103], v[176:179], v[80:95]
    ds_read_b64_tr_b16 v[100:101], v9 offset:28672
    ds_read_b64_tr_b16 v[102:103], v9 offset:29184
    v_mul_f32 v55, v55, v135
    v_cvt_pk_bf16_f32 v56, v48, v49
    v_cvt_pk_bf16_f32 v57, v50, v51
    v_mfma_f32_32x32x16_bf16 v[64:79], v[104:107], v[180:183], v[64:79]
    ds_read_b64_tr_b16 v[104:105], v8 offset:40960
    ds_read_b64_tr_b16 v[106:107], v8 offset:41472
    v_cvt_pk_bf16_f32 v58, v52, v53
    v_cvt_pk_bf16_f32 v59, v54, v55
    v_mfma_f32_32x32x16_bf16 v[80:95], v[108:111], v[180:183], v[80:95]
    ds_read_b64_tr_b16 v[108:109], v9 offset:40960
    ds_read_b64_tr_b16 v[110:111], v9 offset:41472
    v_mfma_f32_32x32x16_bf16 v[64:79], v[112:115], v[184:187], v[64:79]
    ds_read_b64_tr_b16 v[112:113], v8 offset:45056
    ds_read_b64_tr_b16 v[114:115], v8 offset:45568
    v_mfma_f32_32x32x16_bf16 v[80:95], v[116:119], v[184:187], v[80:95]
    s_barrier
    ds_read_b64_tr_b16 v[116:117], v9 offset:45056
    ds_read_b64_tr_b16 v[118:119], v9 offset:45568
    v_add_u32 v8, 0xa000, v8
    v_add_u32 v9, 0xa000, v9
    buffer_store_dwordx4 v[56:59], v6, s[32:35], s88 offen offset:1024 sc1
    s_nop 1
    v_and_b32 v32, 432, v6
    v_cmp_eq_u32 vcc, 0x100, v32
    s_nop 1
    v_cndmask_b32 v32, 0, v10, vcc
    v_mov_b32 v33, v32
    v_mov_b32 v34, v32
    v_mov_b32 v35, v32
    v_mov_b32 v36, v32
    v_mov_b32 v37, v32
    v_mov_b32 v38, v32
    v_mov_b32 v39, v32
    s_add_u32 m0, s86, 125952
    s_nop 0
    buffer_load_dwordx4 v121, s[16:19], s52 offen lds
    v_mov_b32 v40, v32
    v_mov_b32 v41, v32
    v_mov_b32 v42, v32
    v_mov_b32 v43, v32
    v_mov_b32 v44, v32
    v_mov_b32 v45, v32
    v_mov_b32 v46, v32
    v_mov_b32 v47, v32
    v_mov_b32 v48, v32
    v_mov_b32 v49, v32
    s_waitcnt lgkmcnt(0)
    s_barrier
    v_mfma_f32_32x32x16_bf16 v[64:79], v[96:99], v[188:191], v[64:79]
    ds_read_b64_tr_b16 v[96:97], v8 offset:8192
    ds_read_b64_tr_b16 v[98:99], v8 offset:8704
    v_mov_b32 v50, v32
    v_mov_b32 v51, v32
    v_mov_b32 v52, v32
    v_mfma_f32_32x32x16_bf16 v[80:95], v[100:103], v[188:191], v[80:95]
    ds_read_b64_tr_b16 v[100:101], v9 offset:8192
    ds_read_b64_tr_b16 v[102:103], v9 offset:8704
    v_mov_b32 v53, v32
    v_mov_b32 v54, v32
    v_mov_b32 v55, v32
    v_mfma_f32_32x32x16_bf16 v[64:79], v[104:107], v[192:195], v[64:79]
    ds_read_b64_tr_b16 v[104:105], v8 offset:12288
    ds_read_b64_tr_b16 v[106:107], v8 offset:12800
    v_mov_b32 v56, v32
    v_mov_b32 v57, v32
    v_mov_b32 v58, v32
    v_mfma_f32_32x32x16_bf16 v[80:95], v[108:111], v[192:195], v[80:95]
    ds_read_b64_tr_b16 v[108:109], v9 offset:12288
    ds_read_b64_tr_b16 v[110:111], v9 offset:12800
    v_mov_b32 v59, v32
    v_mov_b32 v60, v32
    v_mov_b32 v61, v32
    v_mfma_f32_32x32x16_bf16 v[64:79], v[112:115], v[196:199], v[64:79]
    ds_read_b64_tr_b16 v[112:113], v8 offset:16384
    ds_read_b64_tr_b16 v[114:115], v8 offset:16896
    v_mov_b32 v62, v32
    v_mov_b32 v63, v32
    v_mfma_f32_32x32x16_bf16 v[80:95], v[116:119], v[196:199], v[80:95]
    s_barrier
    ds_read_b64_tr_b16 v[116:117], v9 offset:16384
    ds_read_b64_tr_b16 v[118:119], v9 offset:16896
    buffer_load_dwordx4 v[144:147], v6, s[32:35], s93 offen offset:0 sc1
    buffer_load_dwordx4 v[148:151], v6, s[32:35], s93 offen offset:1024 sc1
    s_waitcnt lgkmcnt(0)
    s_barrier
    v_mfma_f32_32x32x16_bf16 v[64:79], v[96:99], v[200:203], v[64:79]
    ds_read_b64_tr_b16 v[96:97], v8 offset:20480
    ds_read_b64_tr_b16 v[98:99], v8 offset:20992
    v_mfma_f32_32x32x16_bf16 v[80:95], v[100:103], v[200:203], v[80:95]
    ds_read_b64_tr_b16 v[100:101], v9 offset:20480
    ds_read_b64_tr_b16 v[102:103], v9 offset:20992
    v_mfma_f32_32x32x16_bf16 v[64:79], v[104:107], v[204:207], v[64:79]
    ds_read_b64_tr_b16 v[104:105], v8 offset:24576
    ds_read_b64_tr_b16 v[106:107], v8 offset:25088
    v_mfma_f32_32x32x16_bf16 v[80:95], v[108:111], v[204:207], v[80:95]
    ds_read_b64_tr_b16 v[108:109], v9 offset:24576
    ds_read_b64_tr_b16 v[110:111], v9 offset:25088
    v_mfma_f32_32x32x16_bf16 v[64:79], v[112:115], v[208:211], v[64:79]
    ds_read_b64_tr_b16 v[112:113], v8 offset:28672
    ds_read_b64_tr_b16 v[114:115], v8 offset:29184
    s_waitcnt vmcnt(2)
    v_mfma_f32_32x32x16_bf16 v[80:95], v[116:119], v[208:211], v[80:95]
    s_barrier
    ds_read_b64_tr_b16 v[116:117], v9 offset:28672
    ds_read_b64_tr_b16 v[118:119], v9 offset:29184
    v_add_u32 v8, 0xa000, v8
    v_add_u32 v9, 0xa000, v9
    buffer_load_dwordx4 v[152:155], v6, s[32:35], s93 offen offset:2048 sc1
    buffer_load_dwordx4 v[156:159], v6, s[32:35], s93 offen offset:3072 sc1
    s_cmp_lg_u32 s46, 0
    s_cbranch_scc1 L_fl4
    s_mov_b64 exec, 0xffff
    buffer_load_dword v16, v125, s[32:35], s95 offen sc1
    buffer_load_dword v17, v125, s[32:35], s96 offen sc1
    buffer_load_dword v18, v125, s[32:35], s97 offen sc1
    s_mov_b64 exec, -1
L_fl4:
    s_waitcnt lgkmcnt(0)
    s_barrier
    v_mfma_f32_32x32x16_bf16 v[64:79], v[96:99], v[212:215], v[64:79]
    ds_read_b64_tr_b16 v[96:97], v8 offset:0
    ds_read_b64_tr_b16 v[98:99], v8 offset:512
    v_mfma_f32_32x32x16_bf16 v[80:95], v[100:103], v[212:215], v[80:95]
    ds_read_b64_tr_b16 v[100:101], v9 offset:0
    ds_read_b64_tr_b16 v[102:103], v9 offset:512
    v_mfma_f32_32x32x16_bf16 v[64:79], v[104:107], v[216:219], v[64:79]
    ds_read_b64_tr_b16 v[104:105], v8 offset:4096
    ds_read_b64_tr_b16 v[106:107], v8 offset:4608
    v_mfma_f32_32x32x16_bf16 v[80:95], v[108:111], v[216:219], v[80:95]
    ds_read_b64_tr_b16 v[108:109], v9 offset:4096
    ds_read_b64_tr_b16 v[110:111], v9 offset:4608
    v_mfma_f32_32x32x16_bf16 v[64:79], v[112:115], v[220:223], v[64:79]
    ds_read_b64_tr_b16 v[112:113], v8 offset:8192
    ds_read_b64_tr_b16 v[114:115], v8 offset:8704
    v_mfma_f32_32x32x16_bf16 v[80:95], v[116:119], v[220:223], v[80:95]
    s_barrier
    ds_read_b64_tr_b16 v[116:117], v9 offset:8192
    ds_read_b64_tr_b16 v[118:119], v9 offset:8704
    s_cmp_lg_u32 s46, 0
    s_cbranch_scc1 L_ck5
    s_setprio 3
    s_mov_b64 exec, 0xffff
    s_waitcnt vmcnt(0)
L_ck5r_chk:
    v_min3_u32 v20, v16, v17, v18
    v_max3_u32 v21, v16, v17, v18
    v_xor_b32 v20, s50, v20
    v_xor_b32 v21, s50, v21
    v_or_b32 v20, v20, v21
    v_cmp_ne_u32 vcc, 0, v20
    s_cmp_eq_u32 s66, 0
    s_cbranch_scc1 L_ck5r_ok
    s_nop 0
    s_cbranch_vccz L_ck5r_ok
    s_sub_u32 s66, s66, 1
    s_sleep 1
    buffer_load_dword v16, v125, s[32:35], s95 offen sc1
    buffer_load_dword v17, v125, s[32:35], s96 offen sc1
    buffer_load_dword v18, v125, s[32:35], s97 offen sc1
    s_waitcnt vmcnt(0)
    s_branch L_ck5r_chk
L_ck5r_ok:
    s_mov_b64 exec, -1
    s_setprio 0
L_ck5:
    s_waitcnt lgkmcnt(0)
    s_barrier
    v_mfma_f32_32x32x16_bf16 v[64:79], v[96:99], v[224:227], v[64:79]
    ds_read_b64_tr_b16 v[96:97], v8 offset:12288
    ds_read_b64_tr_b16 v[98:99], v8 offset:12800
    v_mfma_f32_32x32x16_bf16 v[80:95], v[100:103], v[224:227], v[80:95]
    ds_read_b64_tr_b16 v[100:101], v9 offset:12288
    ds_read_b64_tr_b16 v[102:103], v9 offset:12800
    v_mfma_f32_32x32x16_bf16 v[64:79], v[104:107], v[228:231], v[64:79]
    ds_read_b64_tr_b16 v[104:105], v8 offset:16384
    ds_read_b64_tr_b16 v[106:107], v8 offset:16896
    v_mfma_f32_32x32x16_bf16 v[80:95], v[108:111], v[228:231], v[80:95]
    ds_read_b64_tr_b16 v[108:109], v9 offset:16384
    ds_read_b64_tr_b16 v[110:111], v9 offset:16896
    v_mfma_f32_32x32x16_bf16 v[64:79], v[112:115], v[232:235], v[64:79]
    ds_read_b64_tr_b16 v[112:113], v8 offset:20480
    ds_read_b64_tr_b16 v[114:115], v8 offset:20992
    v_mfma_f32_32x32x16_bf16 v[80:95], v[116:119], v[232:235], v[80:95]
    s_barrier
    ds_read_b64_tr_b16 v[116:117], v9 offset:20480
    ds_read_b64_tr_b16 v[118:119], v9 offset:20992
    buffer_load_dwordx4 v[24:27], v6, s[32:35], s62 offen sc1
    s_mul_i32 s51, s48, 2097152
    s_add_u32 s51, s51, s56
    s_max_u32 s51, s51, s61
    s_add_u32 m0, s65, 0
    s_nop 0
    buffer_load_dwordx4 v6, s[32:35], s51 offen sc1 lds
    s_add_u32 s61, s61, 4096
    buffer_load_dwordx4 v[224:227], v6, s[32:35], s56 offen sc1
    s_waitcnt vmcnt(3)
L_g2_P_chk:
    v_min3_u32 v140, v147, v151, v155
    v_max3_u32 v141, v147, v151, v155
    v_min3_u32 v140, v140, v159, v159
    v_max3_u32 v141, v141, v159, v159
    v_xor_b32 v140, s50, v140
    v_xor_b32 v141, s50, v141
    v_or_b32 v140, v140, v141
    v_cmp_ne_u32 vcc, 0, v140
    s_cmp_eq_u32 s66, 0
    s_cbranch_scc1 L_g2_P_ok
    s_nop 0
    s_cbranch_vccz L_g2_P_ok
    s_sub_u32 s66, s66, 1
    s_sleep 1
    buffer_load_dwordx4 v[144:147], v6, s[32:35], s93 offen offset:0 sc1
    buffer_load_dwordx4 v[148:151], v6, s[32:35], s93 offen offset:1024 sc1
    buffer_load_dwordx4 v[152:155], v6, s[32:35], s93 offen offset:2048 sc1
    buffer_load_dwordx4 v[156:159], v6, s[32:35], s93 offen offset:3072 sc1
    s_waitcnt vmcnt(0)
    s_branch L_g2_P_chk
L_g2_P_ok:
    s_waitcnt lgkmcnt(0)
    s_barrier
    v_mfma_f32_32x32x16_bf16 v[64:79], v[96:99], v[236:239], v[64:79]
    ds_read_b64_tr_b16 v[96:97], v8 offset:24576
    ds_read_b64_tr_b16 v[98:99], v8 offset:25088
    v_add_f32 v144, v144, v148
    v_add_f32 v152, v152, v156
    v_add_f32 v145, v145, v149
    v_mfma_f32_32x32x16_bf16 v[80:95], v[100:103], v[236:239], v[80:95]
    ds_read_b64_tr_b16 v[100:101], v9 offset:24576
    ds_read_b64_tr_b16 v[102:103], v9 offset:25088
    v_add_f32 v153, v153, v157
    v_add_f32 v144, v144, v152
    v_add_f32 v145, v145, v153
    v_mfma_f32_32x32x16_bf16 v[64:79], v[104:107], v[240:243], v[64:79]
    ds_read_b64_tr_b16 v[104:105], v8 offset:28672
    ds_read_b64_tr_b16 v[106:107], v8 offset:29184
    v_cvt_pk_bf16_f32 v148, v144, v144
    v_cvt_pk_bf16_f32 v149, v145, v145
    v_lshlrev_b32 v148, 16, v148
    v_mfma_f32_32x32x16_bf16 v[80:95], v[108:111], v[240:243], v[80:95]
    ds_read_b64_tr_b16 v[108:109], v9 offset:28672
    ds_read_b64_tr_b16 v[110:111], v9 offset:29184
    v_lshlrev_b32 v149, 16, v149
    v_sub_f32 v148, v144, v148
    v_sub_f32 v149, v145, v149
    v_mfma_f32_32x32x16_bf16 v[64:79], v[112:115], v[244:247], v[64:79]
    v_cvt_pk_bf16_f32 v144, v144, v148
    v_cvt_pk_bf16_f32 v145, v145, v149
    v_mov_b32 v146, 0
    v_mfma_f32_32x32x16_bf16 v[80:95], v[116:119], v[244:247], v[80:95]
    s_barrier
    s_cmp_lg_u32 s46, 0
    s_cbranch_scc1 L_fl6
    s_lshl4_add_u32 s94, s40, s41
    s_lshl_b32 s94, s94, 7
    s_add_u32 s94, s94, 21102592
    s_mov_b64 exec, 1
    buffer_store_dword v124, off, s[32:35], s94 sc1
    s_mov_b64 exec, -1
L_fl6:
    buffer_load_dwordx4 v[228:231], v6, s[32:35], s56 offen offset:1024 sc1
    v_mov_b32 v147, 0
    v_mov_b32 v150, v7
    v_mov_b32 v151, 0
    v_mov_b32 v152, 0
    v_mov_b32 v153, 0
    v_mov_b32 v154, 0
    v_mov_b32 v155, v7
    v_mov_b32 v156, 0
    v_mov_b32 v157, 0
    s_add_u32 m0, s65, 8192
    s_nop 0
    buffer_load_dwordx4 v6, s[32:35], s61 offen sc1 lds
    s_add_u32 s61, s61, 4096
    s_waitcnt lgkmcnt(0)
    s_barrier
    v_mfma_f32_32x32x16_bf16 v[64:79], v[144:147], v[150:153], v[64:79]
    v_mfma_f32_32x32x16_bf16 v[80:95], v[144:147], v[154:157], v[80:95]
    v_mfma_f32_32x32x16_bf16 v[64:79], v[96:99], v[248:251], v[64:79]
    v_mfma_f32_32x32x16_bf16 v[80:95], v[100:103], v[248:251], v[80:95]
    v_mfma_f32_32x32x16_bf16 v[64:79], v[104:107], v[252:255], v[64:79]
    s_waitcnt vmcnt(3)
    v_mfma_f32_32x32x16_bf16 v[80:95], v[108:111], v[252:255], v[80:95]
    s_barrier
    s_branch L_A_done
L_R:
    ds_read_b64_tr_b16 v[96:97], v67 offset:0
    ds_read_b64_tr_b16 v[98:99], v67 offset:512
    ds_read_b64_tr_b16 v[100:101], v67 offset:2048
    ds_read_b64_tr_b16 v[102:103], v67 offset:2560
    ds_read_b64_tr_b16 v[104:105], v67 offset:4096
    ds_read_b64_tr_b16 v[106:107], v67 offset:4608
    ds_read_b64_tr_b16 v[108:109], v67 offset:6144
    ds_read_b64_tr_b16 v[110:111], v67 offset:6656
    ds_read_b64_tr_b16 v[112:113], v67 offset:8192
    ds_read_b64_tr_b16 v[114:115], v67 offset:8704
    ds_read_b64_tr_b16 v[116:117], v67 offset:10240
    ds_read_b64_tr_b16 v[118:119], v67 offset:10752
    s_cmp_lg_u32 s48, 1
    s_cbranch_scc1 L_off_R
    s_barrier
L_off_R:
    ds_read_b128 v[128:131], v68
    ds_read_b128 v[132:135], v69
    s_add_u32 s53, s49, 2
    s_and_b32 s53, s53, 7
    s_lshl_b32 s51, s53, 7
    s_add_u32 m0, s54, 106496
    s_add_u32 s51, s51, s55
    buffer_load_dwordx4 v64, s[4:7], s51 offen lds
    s_add_u32 m0, s54, 106496
    s_lshl3_add_u32 s53, s53, s46
    buffer_load_dwordx4 v65, s[4:7], s51 offen offset:1024 lds
    s_mul_i32 s52, s53, 24576
    s_add_u32 m0, s85, 81920
    s_add_u32 s51, s52, s83
    buffer_load_dwordx4 v66, s[8:11], s51 offen lds
    s_add_u32 m0, s85, 83968
    s_add_u32 s51, s52, s68
    buffer_load_dwordx4 v66, s[8:11], s51 offen lds
    s_add_u32 m0, s85, 86016
    s_add_u32 s51, s51, 128
    buffer_load_dwordx4 v66, s[8:11], s51 offen lds
    s_waitcnt lgkmcnt(0)
    s_barrier
    v_mfma_f32_4x4x4_16b_bf16 v[76:79], v[10:11], v[96:97], 0
    v_mfma_f32_4x4x4_16b_bf16 v[80:83], v[10:11], v[100:101], 0
    v_mfma_f32_4x4x4_16b_bf16 v[84:87], v[10:11], v[104:105], 0
    v_mfma_f32_4x4x4_16b_bf16 v[76:79], v[10:11], v[98:99], v[76:79]
    v_mfma_f32_4x4x4_16b_bf16 v[80:83], v[10:11], v[102:103], v[80:83]
    v_mfma_f32_4x4x4_16b_bf16 v[84:87], v[10:11], v[106:107], v[84:87]
    v_mfma_f32_4x4x4_16b_bf16 v[76:79], v[10:11], v[108:109], v[76:79]
    v_mfma_f32_4x4x4_16b_bf16 v[80:83], v[10:11], v[112:113], v[80:83]
    v_mfma_f32_4x4x4_16b_bf16 v[84:87], v[10:11], v[116:117], v[84:87]
    v_mfma_f32_4x4x4_16b_bf16 v[76:79], v[10:11], v[110:111], v[76:79]
    v_mfma_f32_4x4x4_16b_bf16 v[80:83], v[10:11], v[114:115], v[80:83]
    v_mfma_f32_4x4x4_16b_bf16 v[84:87], v[10:11], v[118:119], v[84:87]
    v_mfma_f32_32x32x16_bf16 v[16:31], v[96:99], v[128:131], 0
    ds_read_b64_tr_b16 v[96:97], v67 offset:12288
    ds_read_b64_tr_b16 v[98:99], v67 offset:12800
    v_mfma_f32_32x32x16_bf16 v[32:47], v[128:131], v[100:103], 0
    ds_read_b64_tr_b16 v[100:101], v67 offset:14336
    ds_read_b64_tr_b16 v[102:103], v67 offset:14848
    v_mfma_f32_32x32x16_bf16 v[48:63], v[128:131], v[104:107], 0
    ds_read_b64_tr_b16 v[104:105], v67 offset:16384
    ds_read_b64_tr_b16 v[106:107], v67 offset:16896
    v_mfma_f32_32x32x16_bf16 v[16:31], v[108:111], v[132:135], v[16:31]
    ds_read_b64_tr_b16 v[108:109], v67 offset:18432
    ds_read_b64_tr_b16 v[110:111], v67 offset:18944
    v_mfma_f32_32x32x16_bf16 v[32:47], v[132:135], v[112:115], v[32:47]
    ds_read_b64_tr_b16 v[112:113], v67 offset:20480
    ds_read_b64_tr_b16 v[114:115], v67 offset:20992
    s_waitcnt vmcnt(5)
    v_mfma_f32_32x32x16_bf16 v[48:63], v[132:135], v[116:119], v[48:63]
    s_barrier
    ds_read_b64_tr_b16 v[116:117], v67 offset:22528
    ds_read_b64_tr_b16 v[118:119], v67 offset:23040
    ds_read_b128 v[136:139], v70
    ds_read_b128 v[140:143], v71
    v_add_u32 v67, 0xa000, v67
    v_add_u32 v8, 0xa000, v8
    v_add_u32 v9, 0xa000, v9
    v_add_u32 v68, 0xa000, v68
    v_add_u32 v69, 0xa000, v69
    v_add_u32 v70, 0xa000, v70
    v_add_u32 v71, 0xa000, v71
    s_add_u32 s53, s49, 3
    s_and_b32 s53, s53, 7
    s_lshl_b32 s51, s53, 7
    s_add_u32 m0, s54, 147456
    s_add_u32 s51, s51, s55
    buffer_load_dwordx4 v64, s[4:7], s51 offen lds
    s_add_u32 m0, s54, 147456
    s_lshl3_add_u32 s53, s53, s46
    buffer_load_dwordx4 v65, s[4:7], s51 offen offset:1024 lds
    s_mul_i32 s52, s53, 24576
    s_add_u32 m0, s85, 122880
    s_add_u32 s51, s52, s83
    buffer_load_dwordx4 v66, s[8:11], s51 offen lds
    s_waitcnt lgkmcnt(0)
    s_barrier
    v_mfma_f32_4x4x4_16b_bf16 v[76:79], v[10:11], v[96:97], v[76:79]
    v_mfma_f32_4x4x4_16b_bf16 v[80:83], v[10:11], v[100:101], v[80:83]
    v_mfma_f32_4x4x4_16b_bf16 v[84:87], v[10:11], v[104:105], v[84:87]
    v_mfma_f32_4x4x4_16b_bf16 v[76:79], v[10:11], v[98:99], v[76:79]
    v_mfma_f32_4x4x4_16b_bf16 v[80:83], v[10:11], v[102:103], v[80:83]
    v_mfma_f32_4x4x4_16b_bf16 v[84:87], v[10:11], v[106:107], v[84:87]
    v_mfma_f32_4x4x4_16b_bf16 v[76:79], v[10:11], v[108:109], v[76:79]
    v_mfma_f32_4x4x4_16b_bf16 v[80:83], v[10:11], v[112:113], v[80:83]
    v_mfma_f32_4x4x4_16b_bf16 v[84:87], v[10:11], v[116:117], v[84:87]
    v_mfma_f32_4x4x4_16b_bf16 v[76:79], v[10:11], v[110:111], v[76:79]
    v_mfma_f32_4x4x4_16b_bf16 v[80:83], v[10:11], v[114:115], v[80:83]
    v_mfma_f32_4x4x4_16b_bf16 v[84:87], v[10:11], v[118:119], v[84:87]
    v_mfma_f32_32x32x16_bf16 v[16:31], v[96:99], v[136:139], v[16:31]
    ds_read_b64_tr_b16 v[96:97], v67 offset:0
    ds_read_b64_tr_b16 v[98:99], v67 offset:512
    v_mfma_f32_32x32x16_bf16 v[32:47], v[136:139], v[100:103], v[32:47]
    ds_read_b64_tr_b16 v[100:101], v67 offset:2048
    ds_read_b64_tr_b16 v[102:103], v67 offset:2560
    v_mfma_f32_32x32x16_bf16 v[48:63], v[136:139], v[104:107], v[48:63]
    ds_read_b64_tr_b16 v[104:105], v67 offset:4096
    ds_read_b64_tr_b16 v[106:107], v67 offset:4608
    v_mfma_f32_32x32x16_bf16 v[16:31], v[108:111], v[140:143], v[16:31]
    ds_read_b64_tr_b16 v[108:109], v67 offset:6144
    ds_read_b64_tr_b16 v[110:111], v67 offset:6656
    v_mfma_f32_32x32x16_bf16 v[32:47], v[140:143], v[112:115], v[32:47]
    ds_read_b64_tr_b16 v[112:113], v67 offset:8192
    ds_read_b64_tr_b16 v[114:115], v67 offset:8704
    v_mfma_f32_32x32x16_bf16 v[48:63], v[140:143], v[116:119], v[48:63]
    s_barrier
    ds_read_b64_tr_b16 v[116:117], v67 offset:10240
    ds_read_b64_tr_b16 v[118:119], v67 offset:10752
    ds_read_b128 v[144:147], v68
    ds_read_b128 v[148:151], v69
    s_cmp_lg_u32 s47, 0
    s_cbranch_scc1 L_cp7
    v_permlane32_swap_b32 v76, v77
    v_permlane32_swap_b32 v80, v81
    v_permlane32_swap_b32 v84, v85
    v_mov_b32 v91, s50
    v_add_f32 v88, v76, v77
    v_add_f32 v89, v80, v81
    v_add_f32 v90, v84, v85
    s_add_u32 s94, s92, 0
    s_mov_b32 exec_hi, 0
    buffer_store_dwordx4 v[88:91], v6, s[32:35], s94 offen sc1
    s_mov_b64 exec, -1
L_cp7:
    s_add_u32 m0, s85, 124928
    s_add_u32 s51, s52, s68
    buffer_load_dwordx4 v66, s[8:11], s51 offen lds
    s_add_u32 m0, s85, 126976
    s_add_u32 s51, s51, 128
    buffer_load_dwordx4 v66, s[8:11], s51 offen lds
    s_add_u32 s53, s49, 4
    s_and_b32 s53, s53, 7
    s_lshl_b32 s51, s53, 7
    s_add_u32 m0, s54, 24576
    s_add_u32 s51, s51, s55
    buffer_load_dwordx4 v64, s[4:7], s51 offen lds
    s_add_u32 m0, s54, 24576
    s_lshl3_add_u32 s53, s53, s46
    buffer_load_dwordx4 v65, s[4:7], s51 offen offset:1024 lds
    s_mul_i32 s52, s53, 24576
    s_add_u32 m0, s85, 0
    s_add_u32 s51, s52, s83
    buffer_load_dwordx4 v66, s[8:11], s51 offen lds
    s_waitcnt lgkmcnt(0)
    s_barrier
    v_mfma_f32_32x32x16_bf16 v[16:31], v[96:99], v[144:147], v[16:31]
    ds_read_b64_tr_b16 v[96:97], v67 offset:12288
    ds_read_b64_tr_b16 v[98:99], v67 offset:12800
    v_mfma_f32_32x32x16_bf16 v[32:47], v[144:147], v[100:103], v[32:47]
    ds_read_b64_tr_b16 v[100:101], v67 offset:14336
    ds_read_b64_tr_b16 v[102:103], v67 offset:14848
    v_mfma_f32_32x32x16_bf16 v[48:63], v[144:147], v[104:107], v[48:63]
    ds_read_b64_tr_b16 v[104:105], v67 offset:16384
    ds_read_b64_tr_b16 v[106:107], v67 offset:16896
    v_mfma_f32_32x32x16_bf16 v[16:31], v[108:111], v[148:151], v[16:31]
    ds_read_b64_tr_b16 v[108:109], v67 offset:18432
    ds_read_b64_tr_b16 v[110:111], v67 offset:18944
    v_mfma_f32_32x32x16_bf16 v[32:47], v[148:151], v[112:115], v[32:47]
    ds_read_b64_tr_b16 v[112:113], v67 offset:20480
    ds_read_b64_tr_b16 v[114:115], v67 offset:20992
    s_waitcnt vmcnt(8)
    v_mfma_f32_32x32x16_bf16 v[48:63], v[148:151], v[116:119], v[48:63]
    s_barrier
    ds_read_b64_tr_b16 v[116:117], v67 offset:22528
    ds_read_b64_tr_b16 v[118:119], v67 offset:23040
    ds_read_b128 v[152:155], v70
    ds_read_b128 v[156:159], v71
    v_add_u32 v67, 0xa000, v67
    v_add_u32 v8, 0xa000, v8
    v_add_u32 v9, 0xa000, v9
    v_add_u32 v68, 0xa000, v68
    v_add_u32 v69, 0xa000, v69
    v_add_u32 v70, 0xa000, v70
    v_add_u32 v71, 0xa000, v71
    s_add_u32 m0, s85, 2048
    s_add_u32 s51, s52, s68
    buffer_load_dwordx4 v66, s[8:11], s51 offen lds
    s_add_u32 m0, s85, 4096
    s_add_u32 s51, s51, 128
    buffer_load_dwordx4 v66, s[8:11], s51 offen lds
    s_waitcnt lgkmcnt(0)
    s_barrier
    v_mfma_f32_32x32x16_bf16 v[16:31], v[96:99], v[152:155], v[16:31]
    ds_read_b64_tr_b16 v[96:97], v67 offset:0
    ds_read_b64_tr_b16 v[98:99], v67 offset:512
    v_mfma_f32_32x32x16_bf16 v[32:47], v[152:155], v[100:103], v[32:47]
    ds_read_b64_tr_b16 v[100:101], v67 offset:2048
    ds_read_b64_tr_b16 v[102:103], v67 offset:2560
    v_mfma_f32_32x32x16_bf16 v[48:63], v[152:155], v[104:107], v[48:63]
    ds_read_b64_tr_b16 v[104:105], v67 offset:4096
    ds_read_b64_tr_b16 v[106:107], v67 offset:4608
    v_mfma_f32_32x32x16_bf16 v[16:31], v[108:111], v[156:159], v[16:31]
    ds_read_b64_tr_b16 v[108:109], v67 offset:6144
    ds_read_b64_tr_b16 v[110:111], v67 offset:6656
    v_mfma_f32_32x32x16_bf16 v[32:47], v[156:159], v[112:115], v[32:47]
    ds_read_b64_tr_b16 v[112:113], v67 offset:8192
    ds_read_b64_tr_b16 v[114:115], v67 offset:8704
    v_mfma_f32_32x32x16_bf16 v[48:63], v[156:159], v[116:119], v[48:63]
    s_barrier
    ds_read_b64_tr_b16 v[116:117], v67 offset:10240
    ds_read_b64_tr_b16 v[118:119], v67 offset:10752
    ds_read_b128 v[160:163], v68
    ds_read_b128 v[164:167], v69
    s_add_u32 s53, s49, 5
    s_and_b32 s53, s53, 7
    s_lshl_b32 s51, s53, 7
    s_add_u32 m0, s54, 65536
    s_add_u32 s51, s51, s55
    buffer_load_dwordx4 v64, s[4:7], s51 offen lds
    s_add_u32 m0, s54, 65536
    s_lshl3_add_u32 s53, s53, s46
    buffer_load_dwordx4 v65, s[4:7], s51 offen offset:1024 lds
    s_mul_i32 s52, s53, 24576
    s_add_u32 m0, s85, 40960
    s_add_u32 s51, s52, s83
    buffer_load_dwordx4 v66, s[8:11], s51 offen lds
    s_waitcnt lgkmcnt(0)
    s_barrier
    v_mfma_f32_32x32x16_bf16 v[16:31], v[96:99], v[160:163], v[16:31]
    ds_read_b64_tr_b16 v[96:97], v67 offset:12288
    ds_read_b64_tr_b16 v[98:99], v67 offset:12800
    v_mfma_f32_32x32x16_bf16 v[32:47], v[160:163], v[100:103], v[32:47]
    ds_read_b64_tr_b16 v[100:101], v67 offset:14336
    ds_read_b64_tr_b16 v[102:103], v67 offset:14848
    v_mfma_f32_32x32x16_bf16 v[48:63], v[160:163], v[104:107], v[48:63]
    ds_read_b64_tr_b16 v[104:105], v67 offset:16384
    ds_read_b64_tr_b16 v[106:107], v67 offset:16896
    v_mfma_f32_32x32x16_bf16 v[16:31], v[108:111], v[164:167], v[16:31]
    ds_read_b64_tr_b16 v[108:109], v67 offset:18432
    ds_read_b64_tr_b16 v[110:111], v67 offset:18944
    v_mfma_f32_32x32x16_bf16 v[32:47], v[164:167], v[112:115], v[32:47]
    ds_read_b64_tr_b16 v[112:113], v67 offset:20480
    ds_read_b64_tr_b16 v[114:115], v67 offset:20992
    s_waitcnt vmcnt(8)
    v_mfma_f32_32x32x16_bf16 v[48:63], v[164:167], v[116:119], v[48:63]
    s_barrier
    ds_read_b64_tr_b16 v[116:117], v67 offset:22528
    ds_read_b64_tr_b16 v[118:119], v67 offset:23040
    ds_read_b128 v[168:171], v70
    ds_read_b128 v[172:175], v71
    v_add_u32 v67, 0xa000, v67
    v_add_u32 v8, 0xa000, v8
    v_add_u32 v9, 0xa000, v9
    v_add_u32 v68, 0xa000, v68
    v_add_u32 v69, 0xa000, v69
    v_add_u32 v70, 0xa000, v70
    v_add_u32 v71, 0xa000, v71
    s_add_u32 m0, s85, 43008
    s_add_u32 s51, s52, s68
    buffer_load_dwordx4 v66, s[8:11], s51 offen lds
    s_add_u32 m0, s85, 45056
    s_add_u32 s51, s51, 128
    buffer_load_dwordx4 v66, s[8:11], s51 offen lds
    s_waitcnt lgkmcnt(0)
    s_barrier
    v_mfma_f32_32x32x16_bf16 v[16:31], v[96:99], v[168:171], v[16:31]
    ds_read_b64_tr_b16 v[96:97], v67 offset:0
    ds_read_b64_tr_b16 v[98:99], v67 offset:512
    v_mfma_f32_32x32x16_bf16 v[32:47], v[168:171], v[100:103], v[32:47]
    ds_read_b64_tr_b16 v[100:101], v67 offset:2048
    ds_read_b64_tr_b16 v[102:103], v67 offset:2560
    v_mfma_f32_32x32x16_bf16 v[48:63], v[168:171], v[104:107], v[48:63]
    ds_read_b64_tr_b16 v[104:105], v67 offset:4096
    ds_read_b64_tr_b16 v[106:107], v67 offset:4608
    v_mfma_f32_32x32x16_bf16 v[16:31], v[108:111], v[172:175], v[16:31]
    ds_read_b64_tr_b16 v[108:109], v67 offset:6144
    ds_read_b64_tr_b16 v[110:111], v67 offset:6656
    v_mfma_f32_32x32x16_bf16 v[32:47], v[172:175], v[112:115], v[32:47]
    ds_read_b64_tr_b16 v[112:113], v67 offset:8192
    ds_read_b64_tr_b16 v[114:115], v67 offset:8704
    v_mfma_f32_32x32x16_bf16 v[48:63], v[172:175], v[116:119], v[48:63]
    s_barrier
    ds_read_b64_tr_b16 v[116:117], v67 offset:10240
    ds_read_b64_tr_b16 v[118:119], v67 offset:10752
    ds_read_b128 v[176:179], v68
    ds_read_b128 v[180:183], v69
    s_add_u32 s53, s49, 6
    s_and_b32 s53, s53, 7
    s_lshl_b32 s51, s53, 7
    s_add_u32 m0, s54, 106496
    s_add_u32 s51, s51, s55
    buffer_load_dwordx4 v64, s[4:7], s51 offen lds
    s_add_u32 m0, s54, 106496
    s_lshl3_add_u32 s53, s53, s46
    buffer_load_dwordx4 v65, s[4:7], s51 offen offset:1024 lds
    s_mul_i32 s52, s53, 24576
    s_add_u32 m0, s85, 81920
    s_add_u32 s51, s52, s83
    buffer_load_dwordx4 v66, s[8:11], s51 offen lds
    s_waitcnt lgkmcnt(0)
    s_barrier
    v_mfma_f32_32x32x16_bf16 v[16:31], v[96:99], v[176:179], v[16:31]
    ds_read_b64_tr_b16 v[96:97], v67 offset:12288
    ds_read_b64_tr_b16 v[98:99], v67 offset:12800
    v_mfma_f32_32x32x16_bf16 v[32:47], v[176:179], v[100:103], v[32:47]
    ds_read_b64_tr_b16 v[100:101], v67 offset:14336
    ds_read_b64_tr_b16 v[102:103], v67 offset:14848
    v_mfma_f32_32x32x16_bf16 v[48:63], v[176:179], v[104:107], v[48:63]
    ds_read_b64_tr_b16 v[104:105], v67 offset:16384
    ds_read_b64_tr_b16 v[106:107], v67 offset:16896
    v_mfma_f32_32x32x16_bf16 v[16:31], v[108:111], v[180:183], v[16:31]
    ds_read_b64_tr_b16 v[108:109], v67 offset:18432
    ds_read_b64_tr_b16 v[110:111], v67 offset:18944
    v_mfma_f32_32x32x16_bf16 v[32:47], v[180:183], v[112:115], v[32:47]
    ds_read_b64_tr_b16 v[112:113], v67 offset:20480
    ds_read_b64_tr_b16 v[114:115], v67 offset:20992
    s_waitcnt vmcnt(8)
    v_mfma_f32_32x32x16_bf16 v[48:63], v[180:183], v[116:119], v[48:63]
    s_barrier
    ds_read_b64_tr_b16 v[116:117], v67 offset:22528
    ds_read_b64_tr_b16 v[118:119], v67 offset:23040
    ds_read_b128 v[184:187], v70
    ds_read_b128 v[188:191], v71
    v_add_u32 v67, 0xfffe2000, v67
    v_add_u32 v8, 0xfffe2000, v8
    v_add_u32 v9, 0xfffe2000, v9
    v_add_u32 v68, 0xfffe2000, v68
    v_add_u32 v69, 0xfffe2000, v69
    v_add_u32 v70, 0xfffe2000, v70
    v_add_u32 v71, 0xfffe2000, v71
    s_add_u32 m0, s85, 83968
    s_add_u32 s51, s52, s68
    buffer_load_dwordx4 v66, s[8:11], s51 offen lds
    s_add_u32 m0, s85, 86016
    s_add_u32 s51, s51, 128
    buffer_load_dwordx4 v66, s[8:11], s51 offen lds
    s_lshl_b32 s94, s59, 9
    s_add_u32 s94, s94, 21037056
    buffer_load_dwordx4 v[72:75], v94, s[32:35], s94 offen sc1
    s_waitcnt lgkmcnt(0)
    s_barrier
    v_mfma_f32_32x32x16_bf16 v[16:31], v[96:99], v[184:187], v[16:31]
    ds_read_b64_tr_b16 v[96:97], v67 offset:0
    ds_read_b64_tr_b16 v[98:99], v67 offset:512
    v_mfma_f32_32x32x16_bf16 v[32:47], v[184:187], v[100:103], v[32:47]
    ds_read_b64_tr_b16 v[100:101], v67 offset:2048
    ds_read_b64_tr_b16 v[102:103], v67 offset:2560
    v_mfma_f32_32x32x16_bf16 v[48:63], v[184:187], v[104:107], v[48:63]
    ds_read_b64_tr_b16 v[104:105], v67 offset:4096
    ds_read_b64_tr_b16 v[106:107], v67 offset:4608
    v_mfma_f32_32x32x16_bf16 v[16:31], v[108:111], v[188:191], v[16:31]
    ds_read_b64_tr_b16 v[108:109], v67 offset:6144
    ds_read_b64_tr_b16 v[110:111], v67 offset:6656
    v_mfma_f32_32x32x16_bf16 v[32:47], v[188:191], v[112:115], v[32:47]
    ds_read_b64_tr_b16 v[112:113], v67 offset:8192
    ds_read_b64_tr_b16 v[114:115], v67 offset:8704
    v_mfma_f32_32x32x16_bf16 v[48:63], v[188:191], v[116:119], v[48:63]
    s_barrier
    ds_read_b64_tr_b16 v[116:117], v67 offset:10240
    ds_read_b64_tr_b16 v[118:119], v67 offset:10752
    ds_read_b128 v[192:195], v68
    ds_read_b128 v[196:199], v69
    s_add_u32 s53, s49, 7
    s_and_b32 s53, s53, 7
    s_lshl_b32 s51, s53, 7
    s_add_u32 m0, s54, 147456
    s_add_u32 s51, s51, s55
    buffer_load_dwordx4 v64, s[4:7], s51 offen lds
    s_add_u32 m0, s54, 147456
    s_lshl3_add_u32 s53, s53, s46
    buffer_load_dwordx4 v65, s[4:7], s51 offen offset:1024 lds
    s_mul_i32 s52, s53, 24576
    s_add_u32 m0, s85, 122880
    s_add_u32 s51, s52, s83
    buffer_load_dwordx4 v66, s[8:11], s51 offen lds
    s_waitcnt lgkmcnt(0)
    s_barrier
    v_mfma_f32_32x32x16_bf16 v[16:31], v[96:99], v[192:195], v[16:31]
    ds_read_b64_tr_b16 v[96:97], v67 offset:12288
    ds_read_b64_tr_b16 v[98:99], v67 offset:12800
    v_mfma_f32_32x32x16_bf16 v[32:47], v[192:195], v[100:103], v[32:47]
    ds_read_b64_tr_b16 v[100:101], v67 offset:14336
    ds_read_b64_tr_b16 v[102:103], v67 offset:14848
    v_mfma_f32_32x32x16_bf16 v[48:63], v[192:195], v[104:107], v[48:63]
    ds_read_b64_tr_b16 v[104:105], v67 offset:16384
    ds_read_b64_tr_b16 v[106:107], v67 offset:16896
    v_mfma_f32_32x32x16_bf16 v[16:31], v[108:111], v[196:199], v[16:31]
    ds_read_b64_tr_b16 v[108:109], v67 offset:18432
    ds_read_b64_tr_b16 v[110:111], v67 offset:18944
    v_mfma_f32_32x32x16_bf16 v[32:47], v[196:199], v[112:115], v[32:47]
    ds_read_b64_tr_b16 v[112:113], v67 offset:20480
    ds_read_b64_tr_b16 v[114:115], v67 offset:20992
    s_waitcnt vmcnt(9)
    v_mfma_f32_32x32x16_bf16 v[48:63], v[196:199], v[116:119], v[48:63]
    s_barrier
    ds_read_b64_tr_b16 v[116:117], v67 offset:22528
    ds_read_b64_tr_b16 v[118:119], v67 offset:23040
    ds_read_b128 v[200:203], v70
    ds_read_b128 v[204:207], v71
    v_add_u32 v67, 0xa000, v67
    v_add_u32 v8, 0xa000, v8
    v_add_u32 v9, 0xa000, v9
    v_add_u32 v68, 0xa000, v68
    v_add_u32 v69, 0xa000, v69
    v_add_u32 v70, 0xa000, v70
    v_add_u32 v71, 0xa000, v71
    s_add_u32 m0, s85, 124928
    s_add_u32 s51, s52, s68
    buffer_load_dwordx4 v66, s[8:11], s51 offen lds
    s_add_u32 m0, s85, 126976
    s_add_u32 s51, s51, 128
    buffer_load_dwordx4 v66, s[8:11], s51 offen lds
    buffer_load_dwordx4 v[76:79], v6, s[32:35], s93 offen offset:0 sc1
    s_waitcnt lgkmcnt(0)
    s_barrier
    v_mfma_f32_32x32x16_bf16 v[16:31], v[96:99], v[200:203], v[16:31]
    ds_read_b64_tr_b16 v[96:97], v67 offset:0
    ds_read_b64_tr_b16 v[98:99], v67 offset:512
    v_mfma_f32_32x32x16_bf16 v[32:47], v[200:203], v[100:103], v[32:47]
    ds_read_b64_tr_b16 v[100:101], v67 offset:2048
    ds_read_b64_tr_b16 v[102:103], v67 offset:2560
    v_mfma_f32_32x32x16_bf16 v[48:63], v[200:203], v[104:107], v[48:63]
    ds_read_b64_tr_b16 v[104:105], v67 offset:4096
    ds_read_b64_tr_b16 v[106:107], v67 offset:4608
    v_mfma_f32_32x32x16_bf16 v[16:31], v[108:111], v[204:207], v[16:31]
    ds_read_b64_tr_b16 v[108:109], v67 offset:6144
    ds_read_b64_tr_b16 v[110:111], v67 offset:6656
    v_mfma_f32_32x32x16_bf16 v[32:47], v[204:207], v[112:115], v[32:47]
    ds_read_b64_tr_b16 v[112:113], v67 offset:8192
    ds_read_b64_tr_b16 v[114:115], v67 offset:8704
    v_mfma_f32_32x32x16_bf16 v[48:63], v[204:207], v[116:119], v[48:63]
    s_barrier
    ds_read_b64_tr_b16 v[116:117], v67 offset:10240
    ds_read_b64_tr_b16 v[118:119], v67 offset:10752
    ds_read_b128 v[208:211], v68
    ds_read_b128 v[212:215], v69
    s_add_u32 s53, s90, 0
    s_and_b32 s53, s53, 7
    s_lshl2_add_u32 s53, s53, s47
    s_mul_i32 s53, s53, 57344
    s_add_u32 s53, s53, s69
    s_add_u32 m0, s86, 0
    s_add_u32 s52, s53, 28672
    buffer_load_dwordx4 v120, s[12:15], s53 offen lds
    buffer_load_dwordx4 v[80:83], v6, s[32:35], s93 offen offset:1024 sc1
    s_waitcnt lgkmcnt(0)
    s_barrier
    v_mfma_f32_32x32x16_bf16 v[16:31], v[96:99], v[208:211], v[16:31]
    ds_read_b64_tr_b16 v[96:97], v67 offset:12288
    ds_read_b64_tr_b16 v[98:99], v67 offset:12800
    v_mfma_f32_32x32x16_bf16 v[32:47], v[208:211], v[100:103], v[32:47]
    ds_read_b64_tr_b16 v[100:101], v67 offset:14336
    ds_read_b64_tr_b16 v[102:103], v67 offset:14848
    v_mfma_f32_32x32x16_bf16 v[48:63], v[208:211], v[104:107], v[48:63]
    ds_read_b64_tr_b16 v[104:105], v67 offset:16384
    ds_read_b64_tr_b16 v[106:107], v67 offset:16896
    v_mfma_f32_32x32x16_bf16 v[16:31], v[108:111], v[212:215], v[16:31]
    ds_read_b64_tr_b16 v[108:109], v67 offset:18432
    ds_read_b64_tr_b16 v[110:111], v67 offset:18944
    v_mfma_f32_32x32x16_bf16 v[32:47], v[212:215], v[112:115], v[32:47]
    ds_read_b64_tr_b16 v[112:113], v67 offset:20480
    ds_read_b64_tr_b16 v[114:115], v67 offset:20992
    s_waitcnt vmcnt(9)
    v_mfma_f32_32x32x16_bf16 v[48:63], v[212:215], v[116:119], v[48:63]
    s_barrier
    ds_read_b64_tr_b16 v[116:117], v67 offset:22528
    ds_read_b64_tr_b16 v[118:119], v67 offset:23040
    ds_read_b128 v[216:219], v70
    ds_read_b128 v[220:223], v71
    v_add_u32 v67, 0xa000, v67
    v_add_u32 v8, 0xa000, v8
    v_add_u32 v9, 0xa000, v9
    v_add_u32 v68, 0xa000, v68
    v_add_u32 v69, 0xa000, v69
    v_add_u32 v70, 0xa000, v70
    v_add_u32 v71, 0xa000, v71
    s_add_u32 m0, s86, 1024
    s_nop 0
    buffer_load_dwordx4 v120, s[12:15], s52 offen lds
    buffer_load_dwordx4 v[84:87], v6, s[32:35], s93 offen offset:2048 sc1
    s_waitcnt lgkmcnt(0)
    s_barrier
    v_mfma_f32_32x32x16_bf16 v[16:31], v[96:99], v[216:219], v[16:31]
    ds_read_b64_tr_b16 v[96:97], v67 offset:0
    ds_read_b64_tr_b16 v[98:99], v67 offset:512
    v_mfma_f32_32x32x16_bf16 v[32:47], v[216:219], v[100:103], v[32:47]
    ds_read_b64_tr_b16 v[100:101], v67 offset:2048
    ds_read_b64_tr_b16 v[102:103], v67 offset:2560
    v_mfma_f32_32x32x16_bf16 v[48:63], v[216:219], v[104:107], v[48:63]
    ds_read_b64_tr_b16 v[104:105], v67 offset:4096
    ds_read_b64_tr_b16 v[106:107], v67 offset:4608
    v_mfma_f32_32x32x16_bf16 v[16:31], v[108:111], v[220:223], v[16:31]
    ds_read_b64_tr_b16 v[108:109], v67 offset:6144
    ds_read_b64_tr_b16 v[110:111], v67 offset:6656
    v_mfma_f32_32x32x16_bf16 v[32:47], v[220:223], v[112:115], v[32:47]
    ds_read_b64_tr_b16 v[112:113], v67 offset:8192
    ds_read_b64_tr_b16 v[114:115], v67 offset:8704
    v_mfma_f32_32x32x16_bf16 v[48:63], v[220:223], v[116:119], v[48:63]
    s_barrier
    ds_read_b64_tr_b16 v[116:117], v67 offset:10240
    ds_read_b64_tr_b16 v[118:119], v67 offset:10752
    ds_read_b128 v[224:227], v68
    ds_read_b128 v[228:231], v69
    s_add_u32 m0, s86, 2048
    s_nop 0
    buffer_load_dwordx4 v121, s[16:19], s53 offen lds
    buffer_load_dwordx4 v[88:91], v6, s[32:35], s93 offen offset:3072 sc1
    s_waitcnt lgkmcnt(0)
    s_barrier
    v_mfma_f32_32x32x16_bf16 v[16:31], v[96:99], v[224:227], v[16:31]
    ds_read_b64_tr_b16 v[96:97], v67 offset:12288
    ds_read_b64_tr_b16 v[98:99], v67 offset:12800
    v_mfma_f32_32x32x16_bf16 v[32:47], v[224:227], v[100:103], v[32:47]
    ds_read_b64_tr_b16 v[100:101], v67 offset:14336
    ds_read_b64_tr_b16 v[102:103], v67 offset:14848
    v_mfma_f32_32x32x16_bf16 v[48:63], v[224:227], v[104:107], v[48:63]
    ds_read_b64_tr_b16 v[104:105], v67 offset:16384
    ds_read_b64_tr_b16 v[106:107], v67 offset:16896
    v_mfma_f32_32x32x16_bf16 v[16:31], v[108:111], v[228:231], v[16:31]
    ds_read_b64_tr_b16 v[108:109], v67 offset:18432
    ds_read_b64_tr_b16 v[110:111], v67 offset:18944
    v_mfma_f32_32x32x16_bf16 v[32:47], v[228:231], v[112:115], v[32:47]
    ds_read_b64_tr_b16 v[112:113], v67 offset:20480
    ds_read_b64_tr_b16 v[114:115], v67 offset:20992
    s_waitcnt vmcnt(7)
    v_mfma_f32_32x32x16_bf16 v[48:63], v[228:231], v[116:119], v[48:63]
    s_barrier
    ds_read_b64_tr_b16 v[116:117], v67 offset:22528
    ds_read_b64_tr_b16 v[118:119], v67 offset:23040
    ds_read_b128 v[232:235], v70
    ds_read_b128 v[236:239], v71
    v_add_u32 v67, 0xa000, v67
    v_add_u32 v8, 0xa000, v8
    v_add_u32 v9, 0xa000, v9
    v_add_u32 v68, 0xa000, v68
    v_add_u32 v69, 0xa000, v69
    v_add_u32 v70, 0xa000, v70
    v_add_u32 v71, 0xa000, v71
    s_add_u32 m0, s86, 3072
    s_nop 0
    buffer_load_dwordx4 v121, s[16:19], s52 offen lds
    s_waitcnt lgkmcnt(0)
    s_barrier
    v_mfma_f32_32x32x16_bf16 v[16:31], v[96:99], v[232:235], v[16:31]
    ds_read_b64_tr_b16 v[96:97], v67 offset:0
    ds_read_b64_tr_b16 v[98:99], v67 offset:512
    v_mfma_f32_32x32x16_bf16 v[32:47], v[232:235], v[100:103], v[32:47]
    ds_read_b64_tr_b16 v[100:101], v67 offset:2048
    ds_read_b64_tr_b16 v[102:103], v67 offset:2560
    v_mfma_f32_32x32x16_bf16 v[48:63], v[232:235], v[104:107], v[48:63]
    ds_read_b64_tr_b16 v[104:105], v67 offset:4096
    ds_read_b64_tr_b16 v[106:107], v67 offset:4608
    v_mfma_f32_32x32x16_bf16 v[16:31], v[108:111], v[236:239], v[16:31]
    ds_read_b64_tr_b16 v[108:109], v67 offset:6144
    ds_read_b64_tr_b16 v[110:111], v67 offset:6656
    v_mfma_f32_32x32x16_bf16 v[32:47], v[236:239], v[112:115], v[32:47]
    ds_read_b64_tr_b16 v[112:113], v67 offset:8192
    ds_read_b64_tr_b16 v[114:115], v67 offset:8704
    v_mfma_f32_32x32x16_bf16 v[48:63], v[236:239], v[116:119], v[48:63]
    s_barrier
    ds_read_b64_tr_b16 v[116:117], v67 offset:10240
    ds_read_b64_tr_b16 v[118:119], v67 offset:10752
    ds_read_b128 v[240:243], v68
    ds_read_b128 v[244:247], v69
    s_add_u32 s53, s90, 2
    s_and_b32 s53, s53, 7
    s_lshl2_add_u32 s53, s53, s47
    s_mul_i32 s53, s53, 57344
    s_add_u32 s53, s53, s69
    s_add_u32 m0, s86, 40960
    s_add_u32 s52, s53, 28672
    buffer_load_dwordx4 v120, s[12:15], s53 offen lds
    s_add_u32 m0, s86, 41984
    s_nop 0
    buffer_load_dwordx4 v120, s[12:15], s52 offen lds
    s_waitcnt vmcnt(3)
L_gr_R_chk:
    v_min3_u32 v92, v75, v79, v83
    v_max3_u32 v95, v75, v79, v83
    v_min3_u32 v92, v92, v87, v91
    v_max3_u32 v95, v95, v87, v91
    v_xor_b32 v92, s50, v92
    v_xor_b32 v95, s50, v95
    v_or_b32 v92, v92, v95
    v_cmp_ne_u32 vcc, 0, v92
    s_cmp_eq_u32 s66, 0
    s_cbranch_scc1 L_gr_R_ok
    s_nop 0
    s_cbranch_vccz L_gr_R_ok
    s_sub_u32 s66, s66, 1
    s_sleep 1
    buffer_load_dwordx4 v[72:75], v94, s[32:35], s94 offen sc1
    buffer_load_dwordx4 v[76:79], v6, s[32:35], s93 offen offset:0 sc1
    buffer_load_dwordx4 v[80:83], v6, s[32:35], s93 offen offset:1024 sc1
    buffer_load_dwordx4 v[84:87], v6, s[32:35], s93 offen offset:2048 sc1
    buffer_load_dwordx4 v[88:91], v6, s[32:35], s93 offen offset:3072 sc1
    s_waitcnt vmcnt(0)
    s_branch L_gr_R_chk
L_gr_R_ok:
    v_mul_f32 v0, 0xbfb8aa3b, v73
    v_mov_b32 v126, v74
    v_mov_b32 v7, v72
    ds_write_b32 v93, v73
    s_waitcnt lgkmcnt(0)
    s_barrier
    v_mfma_f32_32x32x16_bf16 v[16:31], v[96:99], v[240:243], v[16:31]
    ds_read_b64_tr_b16 v[96:97], v67 offset:12288
    ds_read_b64_tr_b16 v[98:99], v67 offset:12800
    v_add_f32 v76, v76, v80
    v_add_f32 v84, v84, v88
    v_add_f32 v77, v77, v81
    v_mfma_f32_32x32x16_bf16 v[32:47], v[240:243], v[100:103], v[32:47]
    ds_read_b64_tr_b16 v[100:101], v67 offset:14336
    ds_read_b64_tr_b16 v[102:103], v67 offset:14848
    v_add_f32 v85, v85, v89
    v_add_f32 v78, v78, v82
    v_add_f32 v86, v86, v90
    v_mfma_f32_32x32x16_bf16 v[48:63], v[240:243], v[104:107], v[48:63]
    ds_read_b64_tr_b16 v[104:105], v67 offset:16384
    ds_read_b64_tr_b16 v[106:107], v67 offset:16896
    v_add_f32 v76, v76, v84
    v_add_f32 v77, v77, v85
    v_add_f32 v78, v78, v86
    v_mfma_f32_32x32x16_bf16 v[16:31], v[108:111], v[244:247], v[16:31]
    ds_read_b64_tr_b16 v[108:109], v67 offset:18432
    ds_read_b64_tr_b16 v[110:111], v67 offset:18944
    v_cvt_pk_bf16_f32 v80, v76, v76
    v_cvt_pk_bf16_f32 v81, v77, v77
    v_cvt_pk_bf16_f32 v82, v78, v78
    v_mfma_f32_32x32x16_bf16 v[32:47], v[244:247], v[112:115], v[32:47]
    ds_read_b64_tr_b16 v[112:113], v67 offset:20480
    ds_read_b64_tr_b16 v[114:115], v67 offset:20992
    v_lshlrev_b32 v80, 16, v80
    v_lshlrev_b32 v81, 16, v81
    v_lshlrev_b32 v82, 16, v82
    s_waitcnt vmcnt(2)
    v_mfma_f32_32x32x16_bf16 v[48:63], v[244:247], v[116:119], v[48:63]
    s_barrier
    ds_read_b64_tr_b16 v[116:117], v67 offset:22528
    ds_read_b64_tr_b16 v[118:119], v67 offset:23040
    ds_read_b128 v[248:251], v70
    ds_read_b128 v[252:255], v71
    v_add_u32 v8, 0xfffe2000, v8
    v_add_u32 v9, 0xfffe2000, v9
    s_add_u32 m0, s86, 43008
    s_nop 0
    buffer_load_dwordx4 v121, s[16:19], s53 offen lds
    s_add_u32 m0, s86, 44032
    s_nop 0
    buffer_load_dwordx4 v121, s[16:19], s52 offen lds
    v_sub_f32 v80, v76, v80
    v_sub_f32 v81, v77, v81
    v_sub_f32 v82, v78, v82
    v_cvt_pk_bf16_f32 v76, v76, v80
    v_cvt_pk_bf16_f32 v77, v77, v81
    v_cvt_pk_bf16_f32 v78, v78, v82
    v_mov_b32 v79, 0
    v_mov_b32 v80, 0
    v_mov_b32 v81, 0
    v_mov_b32 v82, v7
    v_mov_b32 v83, 0
    v_mov_b32 v84, 0
    v_mov_b32 v85, 0
    v_mov_b32 v86, 0
    v_mov_b32 v87, v7
    v_mov_b32 v88, 0
    v_mov_b32 v89, 0
    s_waitcnt lgkmcnt(0)
    s_barrier
    v_mfma_f32_32x32x16_bf16 v[16:31], v[76:79], v[82:85], v[16:31]
    v_mfma_f32_32x32x16_bf16 v[32:47], v[86:89], v[76:79], v[32:47]
    v_mfma_f32_32x32x16_bf16 v[48:63], v[80:83], v[76:79], v[48:63]
    v_mfma_f32_32x32x16_bf16 v[16:31], v[96:99], v[248:251], v[16:31]
    ds_read_b64_tr_b16 v[96:97], v8 offset:0
    ds_read_b64_tr_b16 v[98:99], v8 offset:512
    v_mfma_f32_32x32x16_bf16 v[32:47], v[248:251], v[100:103], v[32:47]
    ds_read_b64_tr_b16 v[100:101], v9 offset:0
    ds_read_b64_tr_b16 v[102:103], v9 offset:512
    v_mfma_f32_32x32x16_bf16 v[48:63], v[248:251], v[104:107], v[48:63]
    ds_read_b64_tr_b16 v[104:105], v8 offset:4096
    ds_read_b64_tr_b16 v[106:107], v8 offset:4608
    v_mfma_f32_32x32x16_bf16 v[16:31], v[108:111], v[252:255], v[16:31]
    ds_read_b64_tr_b16 v[108:109], v9 offset:4096
    ds_read_b64_tr_b16 v[110:111], v9 offset:4608
    v_mfma_f32_32x32x16_bf16 v[32:47], v[252:255], v[112:115], v[32:47]
    ds_read_b64_tr_b16 v[112:113], v8 offset:8192
    ds_read_b64_tr_b16 v[114:115], v8 offset:8704
    v_mfma_f32_32x32x16_bf16 v[48:63], v[252:255], v[116:119], v[48:63]
    s_barrier
    ds_read_b64_tr_b16 v[116:117], v9 offset:8192
    ds_read_b64_tr_b16 v[118:119], v9 offset:8704
    s_add_u32 s53, s90, 4
    s_and_b32 s53, s53, 7
    s_lshl2_add_u32 s53, s53, s47
    s_mul_i32 s53, s53, 57344
    s_add_u32 s53, s53, s69
    s_add_u32 m0, s86, 81920
    s_add_u32 s52, s53, 28672
    buffer_load_dwordx4 v120, s[12:15], s53 offen lds
    v_mul_f32 v3, s87, v0
    s_nop 3
    v_mul_f32 v16, v3, v16
    v_mul_f32 v17, v3, v17
    v_mul_f32 v18, v3, v18
    v_mul_f32 v19, v3, v19
    v_mul_f32 v20, v3, v20
    v_mul_f32 v21, v3, v21
    v_mul_f32 v22, v3, v22
    v_mul_f32 v23, v3, v23
    v_mul_f32 v24, v3, v24
    v_mul_f32 v25, v3, v25
    v_mul_f32 v26, v3, v26
    v_mul_f32 v27, v3, v27
    v_mul_f32 v28, v3, v28
    v_mul_f32 v29, v3, v29
    s_add_u32 m0, s86, 82944
    s_nop 0
    buffer_load_dwordx4 v120, s[12:15], s52 offen lds
    v_mul_f32 v30, v3, v30
    v_mul_f32 v31, v3, v31
    v_cvt_pk_bf16_f32 v16, v16, v17
    v_cvt_pk_bf16_f32 v17, v18, v19
    v_cvt_pk_bf16_f32 v18, v20, v21
    v_cvt_pk_bf16_f32 v19, v22, v23
    v_cvt_pk_bf16_f32 v20, v24, v25
    v_cvt_pk_bf16_f32 v21, v26, v27
    v_cvt_pk_bf16_f32 v22, v28, v29
    v_cvt_pk_bf16_f32 v23, v30, v31
    buffer_store_dwordx4 v[16:19], v6, s[32:35], s64 offen sc1
    s_waitcnt lgkmcnt(0)
    s_barrier
    v_mfma_f32_4x4x4_16b_bf16 v[12:15], v[10:11], v[96:97], 0
    v_mfma_f32_4x4x4_16b_bf16 v[122:125], v[10:11], v[100:101], 0
    s_nop 0
    v_mfma_f32_4x4x4_16b_bf16 v[12:15], v[10:11], v[98:99], v[12:15]
    v_mfma_f32_4x4x4_16b_bf16 v[122:125], v[10:11], v[102:103], v[122:125]
    s_nop 0
    v_mfma_f32_4x4x4_16b_bf16 v[12:15], v[10:11], v[104:105], v[12:15]
    v_mfma_f32_4x4x4_16b_bf16 v[122:125], v[10:11], v[108:109], v[122:125]
    s_nop 0
    v_mfma_f32_4x4x4_16b_bf16 v[12:15], v[10:11], v[106:107], v[12:15]
    v_mfma_f32_4x4x4_16b_bf16 v[122:125], v[10:11], v[110:111], v[122:125]
    s_nop 0
    v_mfma_f32_4x4x4_16b_bf16 v[12:15], v[10:11], v[112:113], v[12:15]
    v_mfma_f32_4x4x4_16b_bf16 v[122:125], v[10:11], v[116:117], v[122:125]
    s_nop 0
    v_mfma_f32_4x4x4_16b_bf16 v[12:15], v[10:11], v[114:115], v[12:15]
    v_mfma_f32_4x4x4_16b_bf16 v[122:125], v[10:11], v[118:119], v[122:125]
    s_nop 0
    v_mfma_f32_32x32x16_bf16 v[64:79], v[96:99], v[128:131], 0
    ds_read_b64_tr_b16 v[96:97], v8 offset:12288
    ds_read_b64_tr_b16 v[98:99], v8 offset:12800
    v_mfma_f32_32x32x16_bf16 v[80:95], v[100:103], v[128:131], 0
    ds_read_b64_tr_b16 v[100:101], v9 offset:12288
    ds_read_b64_tr_b16 v[102:103], v9 offset:12800
    v_mfma_f32_32x32x16_bf16 v[64:79], v[104:107], v[132:135], v[64:79]
    ds_read_b64_tr_b16 v[104:105], v8 offset:16384
    ds_read_b64_tr_b16 v[106:107], v8 offset:16896
    v_mfma_f32_32x32x16_bf16 v[80:95], v[108:111], v[132:135], v[80:95]
    ds_read_b64_tr_b16 v[108:109], v9 offset:16384
    ds_read_b64_tr_b16 v[110:111], v9 offset:16896
    v_mfma_f32_32x32x16_bf16 v[64:79], v[112:115], v[136:139], v[64:79]
    ds_read_b64_tr_b16 v[112:113], v8 offset:20480
    ds_read_b64_tr_b16 v[114:115], v8 offset:20992
    s_waitcnt vmcnt(3)
    v_mfma_f32_32x32x16_bf16 v[80:95], v[116:119], v[136:139], v[80:95]
    s_barrier
    ds_read_b64_tr_b16 v[116:117], v9 offset:20480
    ds_read_b64_tr_b16 v[118:119], v9 offset:20992
    ds_read_b128 v[128:131], v5 offset:0
    ds_read_b128 v[132:135], v5 offset:32
    ds_read_b128 v[24:27], v5 offset:64
    ds_read_b128 v[28:31], v5 offset:96
    s_add_u32 s64, s64, 65536
    buffer_store_dwordx4 v[20:23], v6, s[32:35], s64 offen sc1
    s_waitcnt lgkmcnt(0)
    v_mul_f32 v32, v128, v32
    v_mul_f32 v33, v129, v33
    v_mul_f32 v34, v130, v34
    v_mul_f32 v35, v131, v35
    v_mul_f32 v36, v132, v36
    v_mul_f32 v37, v133, v37
    v_mul_f32 v38, v134, v38
    v_mul_f32 v39, v135, v39
    v_cvt_pk_bf16_f32 v32, v32, v33
    v_cvt_pk_bf16_f32 v33, v34, v35
    v_cvt_pk_bf16_f32 v34, v36, v37
    v_cvt_pk_bf16_f32 v35, v38, v39
    s_add_u32 m0, s86, 83968
    s_nop 0
    buffer_load_dwordx4 v121, s[16:19], s53 offen lds
    v_mul_f32 v40, v24, v40
    v_mul_f32 v41, v25, v41
    v_mul_f32 v42, v26, v42
    v_mul_f32 v43, v27, v43
    v_mul_f32 v44, v28, v44
    v_mul_f32 v45, v29, v45
    v_mul_f32 v46, v30, v46
    v_mul_f32 v47, v31, v47
    v_cvt_pk_bf16_f32 v40, v40, v41
    v_cvt_pk_bf16_f32 v41, v42, v43
    v_cvt_pk_bf16_f32 v42, v44, v45
    v_cvt_pk_bf16_f32 v43, v46, v47
    v_mul_f32 v48, v128, v48
    v_mul_f32 v49, v129, v49
    v_mul_f32 v50, v130, v50
    v_mul_f32 v51, v131, v51
    buffer_store_dwordx4 v[32:35], v2, s[32:35], s88 offen offset:0 sc1
    s_waitcnt lgkmcnt(0)
    s_barrier
    v_mfma_f32_4x4x4_16b_bf16 v[12:15], v[10:11], v[96:97], v[12:15]
    v_mfma_f32_4x4x4_16b_bf16 v[122:125], v[10:11], v[100:101], v[122:125]
    s_nop 0
    v_mfma_f32_4x4x4_16b_bf16 v[12:15], v[10:11], v[98:99], v[12:15]
    v_mfma_f32_4x4x4_16b_bf16 v[122:125], v[10:11], v[102:103], v[122:125]
    s_nop 0
    v_mfma_f32_32x32x16_bf16 v[64:79], v[96:99], v[140:143], v[64:79]
    ds_read_b64_tr_b16 v[96:97], v8 offset:24576
    ds_read_b64_tr_b16 v[98:99], v8 offset:25088
    v_mul_f32 v52, v132, v52
    v_mul_f32 v53, v133, v53
    v_mul_f32 v54, v134, v54
    v_mfma_f32_32x32x16_bf16 v[80:95], v[100:103], v[140:143], v[80:95]
    ds_read_b64_tr_b16 v[100:101], v9 offset:24576
    ds_read_b64_tr_b16 v[102:103], v9 offset:25088
    v_mul_f32 v55, v135, v55
    v_cvt_pk_bf16_f32 v48, v48, v49
    v_cvt_pk_bf16_f32 v49, v50, v51
    v_mfma_f32_32x32x16_bf16 v[64:79], v[104:107], v[144:147], v[64:79]
    ds_read_b64_tr_b16 v[104:105], v8 offset:28672
    ds_read_b64_tr_b16 v[106:107], v8 offset:29184
    v_cvt_pk_bf16_f32 v50, v52, v53
    v_cvt_pk_bf16_f32 v51, v54, v55
    v_mul_f32 v56, v24, v56
    v_mfma_f32_32x32x16_bf16 v[80:95], v[108:111], v[144:147], v[80:95]
    ds_read_b64_tr_b16 v[108:109], v9 offset:28672
    ds_read_b64_tr_b16 v[110:111], v9 offset:29184
    v_mul_f32 v57, v25, v57
    v_mul_f32 v58, v26, v58
    v_mul_f32 v59, v27, v59
    v_mfma_f32_32x32x16_bf16 v[64:79], v[112:115], v[148:151], v[64:79]
    ds_read_b64_tr_b16 v[112:113], v8 offset:40960
    ds_read_b64_tr_b16 v[114:115], v8 offset:41472
    v_mul_f32 v60, v28, v60
    v_mul_f32 v61, v29, v61
    v_mul_f32 v62, v30, v62
    v_mfma_f32_32x32x16_bf16 v[80:95], v[116:119], v[148:151], v[80:95]
    s_barrier
    ds_read_b64_tr_b16 v[116:117], v9 offset:40960
    ds_read_b64_tr_b16 v[118:119], v9 offset:41472
    s_cmp_lg_u32 s47, 0
    s_cbranch_scc1 L_cp8
    v_permlane32_swap_b32 v12, v13
    v_permlane32_swap_b32 v122, v123
    v_mov_b32 v143, s50
    v_add_f32 v140, v12, v13
    v_add_f32 v141, v122, v123
    s_add_u32 s94, s92, 262144
    s_mov_b32 exec_hi, 0
    buffer_store_dwordx4 v[140:143], v6, s[32:35], s94 offen sc1
    s_mov_b64 exec, -1
L_cp8:
    s_add_u32 s93, s93, 262144
    v_mov_b32 v124, s50
    v_lshlrev_b32 v125, 3, v6
    v_add_u32 v122, s84, v6
    v_add_u32 v123, 7168, v4
    v_add_u32 v8, 0xa000, v8
    v_add_u32 v9, 0xa000, v9
    buffer_store_dwordx4 v[40:43], v2, s[32:35], s88 offen offset:256 sc1
    v_mul_f32 v63, v31, v63
    v_cvt_pk_bf16_f32 v56, v56, v57
    v_cvt_pk_bf16_f32 v57, v58, v59
    v_cvt_pk_bf16_f32 v58, v60, v61
    v_cvt_pk_bf16_f32 v59, v62, v63
    s_add_u32 m0, s86, 84992
    s_nop 0
    buffer_load_dwordx4 v121, s[16:19], s52 offen lds
    s_add_u32 s88, s88, 262144
    buffer_store_dwordx4 v[48:51], v2, s[32:35], s88 offen offset:0 sc1
    s_waitcnt lgkmcnt(0)
    s_barrier
    v_mfma_f32_32x32x16_bf16 v[64:79], v[96:99], v[152:155], v[64:79]
    ds_read_b64_tr_b16 v[96:97], v8 offset:4096
    ds_read_b64_tr_b16 v[98:99], v8 offset:4608
    v_mfma_f32_32x32x16_bf16 v[80:95], v[100:103], v[152:155], v[80:95]
    ds_read_b64_tr_b16 v[100:101], v9 offset:4096
    ds_read_b64_tr_b16 v[102:103], v9 offset:4608
    v_mfma_f32_32x32x16_bf16 v[64:79], v[104:107], v[156:159], v[64:79]
    ds_read_b64_tr_b16 v[104:105], v8 offset:8192
    ds_read_b64_tr_b16 v[106:107], v8 offset:8704
    v_mfma_f32_32x32x16_bf16 v[80:95], v[108:111], v[156:159], v[80:95]
    ds_read_b64_tr_b16 v[108:109], v9 offset:8192
    ds_read_b64_tr_b16 v[110:111], v9 offset:8704
    v_mfma_f32_32x32x16_bf16 v[64:79], v[112:115], v[160:163], v[64:79]
    ds_read_b64_tr_b16 v[112:113], v8 offset:12288
    ds_read_b64_tr_b16 v[114:115], v8 offset:12800
    v_mfma_f32_32x32x16_bf16 v[80:95], v[116:119], v[160:163], v[80:95]
    s_barrier
    ds_read_b64_tr_b16 v[116:117], v9 offset:12288
    ds_read_b64_tr_b16 v[118:119], v9 offset:12800
    buffer_store_dwordx4 v[56:59], v2, s[32:35], s88 offen offset:256 sc1
    s_nop 1
    v_and_b32 v32, 432, v6
    v_cmp_eq_u32 vcc, 0x100, v32
    s_nop 1
    v_cndmask_b32 v32, 0, v10, vcc
    v_mov_b32 v33, v32
    v_mov_b32 v34, v32
    v_mov_b32 v35, v32
    v_mov_b32 v36, v32
    v_mov_b32 v37, v32
    v_mov_b32 v38, v32
    v_mov_b32 v39, v32
    v_mov_b32 v40, v32
    v_mov_b32 v41, v32
    v_mov_b32 v42, v32
    v_mov_b32 v43, v32
    v_mov_b32 v44, v32
    v_mov_b32 v45, v32
    s_add_u32 s53, s90, 6
    s_and_b32 s53, s53, 7
    s_lshl2_add_u32 s53, s53, s47
    s_mul_i32 s53, s53, 57344
    s_add_u32 s53, s53, s69
    s_add_u32 m0, s86, 122880
    s_add_u32 s52, s53, 28672
    buffer_load_dwordx4 v120, s[12:15], s53 offen lds
    v_mov_b32 v46, v32
    v_mov_b32 v47, v32
    v_mov_b32 v48, v32
    v_mov_b32 v49, v32
    v_mov_b32 v50, v32
    v_mov_b32 v51, v32
    v_mov_b32 v52, v32
    v_mov_b32 v53, v32
    v_mov_b32 v54, v32
    v_mov_b32 v55, v32
    v_mov_b32 v56, v32
    v_mov_b32 v57, v32
    v_mov_b32 v58, v32
    v_mov_b32 v59, v32
    v_mov_b32 v60, v32
    v_mov_b32 v61, v32
    s_waitcnt lgkmcnt(0)
    s_barrier
    v_mfma_f32_32x32x16_bf16 v[64:79], v[96:99], v[164:167], v[64:79]
    ds_read_b64_tr_b16 v[96:97], v8 offset:16384
    ds_read_b64_tr_b16 v[98:99], v8 offset:16896
    v_mov_b32 v62, v32
    v_mov_b32 v63, v32
    v_mfma_f32_32x32x16_bf16 v[80:95], v[100:103], v[164:167], v[80:95]
    ds_read_b64_tr_b16 v[100:101], v9 offset:16384
    ds_read_b64_tr_b16 v[102:103], v9 offset:16896
    v_mfma_f32_32x32x16_bf16 v[64:79], v[104:107], v[168:171], v[64:79]
    ds_read_b64_tr_b16 v[104:105], v8 offset:20480
    ds_read_b64_tr_b16 v[106:107], v8 offset:20992
    v_mfma_f32_32x32x16_bf16 v[80:95], v[108:111], v[168:171], v[80:95]
    ds_read_b64_tr_b16 v[108:109], v9 offset:20480
    ds_read_b64_tr_b16 v[110:111], v9 offset:20992
    v_mfma_f32_32x32x16_bf16 v[64:79], v[112:115], v[172:175], v[64:79]
    ds_read_b64_tr_b16 v[112:113], v8 offset:24576
    ds_read_b64_tr_b16 v[114:115], v8 offset:25088
    s_waitcnt vmcnt(3)
    v_mfma_f32_32x32x16_bf16 v[80:95], v[116:119], v[172:175], v[80:95]
    s_barrier
    ds_read_b64_tr_b16 v[116:117], v9 offset:24576
    ds_read_b64_tr_b16 v[118:119], v9 offset:25088
    s_add_u32 m0, s86, 123904
    s_nop 0
    buffer_load_dwordx4 v120, s[12:15], s52 offen lds
    s_add_u32 m0, s86, 124928
    s_nop 0
    buffer_load_dwordx4 v121, s[16:19], s53 offen lds
    s_waitcnt vmcnt(3)
    s_waitcnt lgkmcnt(0)
    s_barrier
    v_mfma_f32_32x32x16_bf16 v[64:79], v[96:99], v[176:179], v[64:79]
    ds_read_b64_tr_b16 v[96:97], v8 offset:28672
    ds_read_b64_tr_b16 v[98:99], v8 offset:29184
    v_mfma_f32_32x32x16_bf16 v[80:95], v[100:103], v[176:179], v[80:95]
    ds_read_b64_tr_b16 v[100:101], v9 offset:28672
    ds_read_b64_tr_b16 v[102:103], v9 offset:29184
    v_mfma_f32_32x32x16_bf16 v[64:79], v[104:107], v[180:183], v[64:79]
    ds_read_b64_tr_b16 v[104:105], v8 offset:40960
    ds_read_b64_tr_b16 v[106:107], v8 offset:41472
    v_mfma_f32_32x32x16_bf16 v[80:95], v[108:111], v[180:183], v[80:95]
    ds_read_b64_tr_b16 v[108:109], v9 offset:40960
    ds_read_b64_tr_b16 v[110:111], v9 offset:41472
    v_mfma_f32_32x32x16_bf16 v[64:79], v[112:115], v[184:187], v[64:79]
    ds_read_b64_tr_b16 v[112:113], v8 offset:45056
    ds_read_b64_tr_b16 v[114:115], v8 offset:45568
    v_mfma_f32_32x32x16_bf16 v[80:95], v[116:119], v[184:187], v[80:95]
    s_barrier
    ds_read_b64_tr_b16 v[116:117], v9 offset:45056
    ds_read_b64_tr_b16 v[118:119], v9 offset:45568
    s_cmp_lg_u32 s46, 0
    s_cbranch_scc1 L_fl9
    s_lshl4_add_u32 s94, s41, s40
    s_lshl_b32 s94, s94, 7
    s_add_u32 s94, s94, 20971520
    s_mov_b64 exec, 1
    buffer_store_dword v124, off, s[32:35], s94 sc1
    s_mov_b64 exec, -1
L_fl9:
    v_add_u32 v8, 0xa000, v8
    v_add_u32 v9, 0xa000, v9
    s_add_u32 m0, s86, 125952
    s_nop 0
    buffer_load_dwordx4 v121, s[16:19], s52 offen lds
    s_waitcnt lgkmcnt(0)
    s_barrier
    v_mfma_f32_32x32x16_bf16 v[64:79], v[96:99], v[188:191], v[64:79]
    ds_read_b64_tr_b16 v[96:97], v8 offset:8192
    ds_read_b64_tr_b16 v[98:99], v8 offset:8704
    v_mfma_f32_32x32x16_bf16 v[80:95], v[100:103], v[188:191], v[80:95]
    ds_read_b64_tr_b16 v[100:101], v9 offset:8192
    ds_read_b64_tr_b16 v[102:103], v9 offset:8704
    v_mfma_f32_32x32x16_bf16 v[64:79], v[104:107], v[192:195], v[64:79]
    ds_read_b64_tr_b16 v[104:105], v8 offset:12288
    ds_read_b64_tr_b16 v[106:107], v8 offset:12800
    v_mfma_f32_32x32x16_bf16 v[80:95], v[108:111], v[192:195], v[80:95]
    ds_read_b64_tr_b16 v[108:109], v9 offset:12288
    ds_read_b64_tr_b16 v[110:111], v9 offset:12800
    v_mfma_f32_32x32x16_bf16 v[64:79], v[112:115], v[196:199], v[64:79]
    ds_read_b64_tr_b16 v[112:113], v8 offset:16384
    ds_read_b64_tr_b16 v[114:115], v8 offset:16896
    v_mfma_f32_32x32x16_bf16 v[80:95], v[116:119], v[196:199], v[80:95]
    s_barrier
    ds_read_b64_tr_b16 v[116:117], v9 offset:16384
    ds_read_b64_tr_b16 v[118:119], v9 offset:16896
    buffer_load_dwordx4 v[144:147], v6, s[32:35], s93 offen offset:0 sc1
    buffer_load_dwordx4 v[148:151], v6, s[32:35], s93 offen offset:1024 sc1
    s_waitcnt lgkmcnt(0)
    s_barrier
    v_mfma_f32_32x32x16_bf16 v[64:79], v[96:99], v[200:203], v[64:79]
    ds_read_b64_tr_b16 v[96:97], v8 offset:20480
    ds_read_b64_tr_b16 v[98:99], v8 offset:20992
    v_mfma_f32_32x32x16_bf16 v[80:95], v[100:103], v[200:203], v[80:95]
    ds_read_b64_tr_b16 v[100:101], v9 offset:20480
    ds_read_b64_tr_b16 v[102:103], v9 offset:20992
    v_mfma_f32_32x32x16_bf16 v[64:79], v[104:107], v[204:207], v[64:79]
    ds_read_b64_tr_b16 v[104:105], v8 offset:24576
    ds_read_b64_tr_b16 v[106:107], v8 offset:25088
    v_mfma_f32_32x32x16_bf16 v[80:95], v[108:111], v[204:207], v[80:95]
    ds_read_b64_tr_b16 v[108:109], v9 offset:24576
    ds_read_b64_tr_b16 v[110:111], v9 offset:25088
    v_mfma_f32_32x32x16_bf16 v[64:79], v[112:115], v[208:211], v[64:79]
    ds_read_b64_tr_b16 v[112:113], v8 offset:28672
    ds_read_b64_tr_b16 v[114:115], v8 offset:29184
    s_waitcnt vmcnt(2)
    v_mfma_f32_32x32x16_bf16 v[80:95], v[116:119], v[208:211], v[80:95]
    s_barrier
    ds_read_b64_tr_b16 v[116:117], v9 offset:28672
    ds_read_b64_tr_b16 v[118:119], v9 offset:29184
    v_add_u32 v8, 0xa000, v8
    v_add_u32 v9, 0xa000, v9
    buffer_load_dwordx4 v[152:155], v6, s[32:35], s93 offen offset:2048 sc1
    buffer_load_dwordx4 v[156:159], v6, s[32:35], s93 offen offset:3072 sc1
    s_cmp_lg_u32 s46, 0
    s_cbranch_scc1 L_fl10
    s_mov_b64 exec, 0xffff
    buffer_load_dword v16, v125, s[32:35], s95 offen sc1
    buffer_load_dword v17, v125, s[32:35], s96 offen sc1
    buffer_load_dword v18, v125, s[32:35], s97 offen sc1
    s_mov_b64 exec, -1
L_fl10:
    s_waitcnt lgkmcnt(0)
    s_barrier
    v_mfma_f32_32x32x16_bf16 v[64:79], v[96:99], v[212:215], v[64:79]
    ds_read_b64_tr_b16 v[96:97], v8 offset:0
    ds_read_b64_tr_b16 v[98:99], v8 offset:512
    v_mfma_f32_32x32x16_bf16 v[80:95], v[100:103], v[212:215], v[80:95]
    ds_read_b64_tr_b16 v[100:101], v9 offset:0
    ds_read_b64_tr_b16 v[102:103], v9 offset:512
    v_mfma_f32_32x32x16_bf16 v[64:79], v[104:107], v[216:219], v[64:79]
    ds_read_b64_tr_b16 v[104:105], v8 offset:4096
    ds_read_b64_tr_b16 v[106:107], v8 offset:4608
    v_mfma_f32_32x32x16_bf16 v[80:95], v[108:111], v[216:219], v[80:95]
    ds_read_b64_tr_b16 v[108:109], v9 offset:4096
    ds_read_b64_tr_b16 v[110:111], v9 offset:4608
    v_mfma_f32_32x32x16_bf16 v[64:79], v[112:115], v[220:223], v[64:79]
    ds_read_b64_tr_b16 v[112:113], v8 offset:8192
    ds_read_b64_tr_b16 v[114:115], v8 offset:8704
    v_mfma_f32_32x32x16_bf16 v[80:95], v[116:119], v[220:223], v[80:95]
    s_barrier
    ds_read_b64_tr_b16 v[116:117], v9 offset:8192
    ds_read_b64_tr_b16 v[118:119], v9 offset:8704
    s_cmp_lg_u32 s46, 0
    s_cbranch_scc1 L_ck11
    s_setprio 3
    s_mov_b64 exec, 0xffff
    s_waitcnt vmcnt(0)
L_ck11r_chk:
    v_min3_u32 v20, v16, v17, v18
    v_max3_u32 v21, v16, v17, v18
    v_xor_b32 v20, s50, v20
    v_xor_b32 v21, s50, v21
    v_or_b32 v20, v20, v21
    v_cmp_ne_u32 vcc, 0, v20
    s_cmp_eq_u32 s66, 0
    s_cbranch_scc1 L_ck11r_ok
    s_nop 0
    s_cbranch_vccz L_ck11r_ok
    s_sub_u32 s66, s66, 1
    s_sleep 1
    buffer_load_dword v16, v125, s[32:35], s95 offen sc1
    buffer_load_dword v17, v125, s[32:35], s96 offen sc1
    buffer_load_dword v18, v125, s[32:35], s97 offen sc1
    s_waitcnt vmcnt(0)
    s_branch L_ck11r_chk
L_ck11r_ok:
    s_mov_b64 exec, -1
    s_setprio 0
L_ck11:
    s_waitcnt lgkmcnt(0)
    s_barrier
    v_mfma_f32_32x32x16_bf16 v[64:79], v[96:99], v[224:227], v[64:79]
    ds_read_b64_tr_b16 v[96:97], v8 offset:12288
    ds_read_b64_tr_b16 v[98:99], v8 offset:12800
    v_mfma_f32_32x32x16_bf16 v[80:95], v[100:103], v[224:227], v[80:95]
    ds_read_b64_tr_b16 v[100:101], v9 offset:12288
    ds_read_b64_tr_b16 v[102:103], v9 offset:12800
    v_mfma_f32_32x32x16_bf16 v[64:79], v[104:107], v[228:231], v[64:79]
    ds_read_b64_tr_b16 v[104:105], v8 offset:16384
    ds_read_b64_tr_b16 v[106:107], v8 offset:16896
    v_mfma_f32_32x32x16_bf16 v[80:95], v[108:111], v[228:231], v[80:95]
    ds_read_b64_tr_b16 v[108:109], v9 offset:16384
    ds_read_b64_tr_b16 v[110:111], v9 offset:16896
    v_mfma_f32_32x32x16_bf16 v[64:79], v[112:115], v[232:235], v[64:79]
    ds_read_b64_tr_b16 v[112:113], v8 offset:20480
    ds_read_b64_tr_b16 v[114:115], v8 offset:20992
    v_mfma_f32_32x32x16_bf16 v[80:95], v[116:119], v[232:235], v[80:95]
    s_barrier
    ds_read_b64_tr_b16 v[116:117], v9 offset:20480
    ds_read_b64_tr_b16 v[118:119], v9 offset:20992
    buffer_load_dwordx4 v[24:27], v6, s[32:35], s62 offen sc1
    s_mul_i32 s51, s48, 2097152
    s_add_u32 s51, s51, s56
    s_max_u32 s51, s51, s61
    s_add_u32 m0, s65, 0
    s_nop 0
    buffer_load_dwordx4 v6, s[32:35], s51 offen sc1 lds
    s_add_u32 s61, s61, 4096
    buffer_load_dwordx4 v[224:227], v6, s[32:35], s56 offen sc1
    s_waitcnt vmcnt(3)
L_g2_R_chk:
    v_min3_u32 v140, v147, v151, v155
    v_max3_u32 v141, v147, v151, v155
    v_min3_u32 v140, v140, v159, v159
    v_max3_u32 v141, v141, v159, v159
    v_xor_b32 v140, s50, v140
    v_xor_b32 v141, s50, v141
    v_or_b32 v140, v140, v141
    v_cmp_ne_u32 vcc, 0, v140
    s_cmp_eq_u32 s66, 0
    s_cbranch_scc1 L_g2_R_ok
    s_nop 0
    s_cbranch_vccz L_g2_R_ok
    s_sub_u32 s66, s66, 1
    s_sleep 1
    buffer_load_dwordx4 v[144:147], v6, s[32:35], s93 offen offset:0 sc1
    buffer_load_dwordx4 v[148:151], v6, s[32:35], s93 offen offset:1024 sc1
    buffer_load_dwordx4 v[152:155], v6, s[32:35], s93 offen offset:2048 sc1
    buffer_load_dwordx4 v[156:159], v6, s[32:35], s93 offen offset:3072 sc1
    s_waitcnt vmcnt(0)
    s_branch L_g2_R_chk
L_g2_R_ok:
    s_waitcnt lgkmcnt(0)
    s_barrier
    v_mfma_f32_32x32x16_bf16 v[64:79], v[96:99], v[236:239], v[64:79]
    ds_read_b64_tr_b16 v[96:97], v8 offset:24576
    ds_read_b64_tr_b16 v[98:99], v8 offset:25088
    v_add_f32 v144, v144, v148
    v_add_f32 v152, v152, v156
    v_add_f32 v145, v145, v149
    v_mfma_f32_32x32x16_bf16 v[80:95], v[100:103], v[236:239], v[80:95]
    ds_read_b64_tr_b16 v[100:101], v9 offset:24576
    ds_read_b64_tr_b16 v[102:103], v9 offset:25088
    v_add_f32 v153, v153, v157
    v_add_f32 v144, v144, v152
    v_add_f32 v145, v145, v153
    v_mfma_f32_32x32x16_bf16 v[64:79], v[104:107], v[240:243], v[64:79]
    ds_read_b64_tr_b16 v[104:105], v8 offset:28672
    ds_read_b64_tr_b16 v[106:107], v8 offset:29184
    v_cvt_pk_bf16_f32 v148, v144, v144
    v_cvt_pk_bf16_f32 v149, v145, v145
    v_lshlrev_b32 v148, 16, v148
    v_mfma_f32_32x32x16_bf16 v[80:95], v[108:111], v[240:243], v[80:95]
    ds_read_b64_tr_b16 v[108:109], v9 offset:28672
    ds_read_b64_tr_b16 v[110:111], v9 offset:29184
    v_lshlrev_b32 v149, 16, v149
    v_sub_f32 v148, v144, v148
    v_sub_f32 v149, v145, v149
    v_mfma_f32_32x32x16_bf16 v[64:79], v[112:115], v[244:247], v[64:79]
    v_cvt_pk_bf16_f32 v144, v144, v148
    v_cvt_pk_bf16_f32 v145, v145, v149
    v_mov_b32 v146, 0
    v_mfma_f32_32x32x16_bf16 v[80:95], v[116:119], v[244:247], v[80:95]
    s_barrier
    buffer_load_dwordx4 v[228:231], v6, s[32:35], s56 offen offset:1024 sc1
    v_mov_b32 v147, 0
    v_mov_b32 v150, v7
    v_mov_b32 v151, 0
    v_mov_b32 v152, 0
    v_mov_b32 v153, 0
    v_mov_b32 v154, 0
    v_mov_b32 v155, v7
    v_mov_b32 v156, 0
    v_mov_b32 v157, 0
    s_add_u32 m0, s65, 8192
    s_nop 0
    buffer_load_dwordx4 v6, s[32:35], s61 offen sc1 lds
    s_add_u32 s61, s61, 4096
    s_waitcnt lgkmcnt(0)
    s_barrier
    v_mfma_f32_32x32x16_bf16 v[64:79], v[144:147], v[150:153], v[64:79]
    v_mfma_f32_32x32x16_bf16 v[80:95], v[144:147], v[154:157], v[80:95]
    v_mfma_f32_32x32x16_bf16 v[64:79], v[96:99], v[248:251], v[64:79]
    v_mfma_f32_32x32x16_bf16 v[80:95], v[100:103], v[248:251], v[80:95]
    v_mfma_f32_32x32x16_bf16 v[64:79], v[104:107], v[252:255], v[64:79]
    s_waitcnt vmcnt(3)
    v_mfma_f32_32x32x16_bf16 v[80:95], v[108:111], v[252:255], v[80:95]
    s_barrier
L_A_done:
    s_lshr_b32 s95, s44, 1
    s_lshl_b32 s95, s95, 11
    s_add_u32 s95, s95, 21102592
    s_add_u32 s96, s95, 32768
    s_cmp_lg_u32 s46, 4
    s_cbranch_scc1 L_fl12
    s_mov_b64 exec, 0xfff
    buffer_load_dword v16, v125, s[32:35], s95 offen sc1
    s_mov_b64 exec, -1
L_fl12:
    v_mov_b32 v96, 0
    v_mov_b32 v97, 0
    v_mov_b32 v98, 0
    v_mov_b32 v99, 0
    s_nop 2
    s_lshl_b32 s53, s46, 13
    v_and_b32 v2, 0x380, v6
    v_and_b32 v19, 0x70, v6
    v_lshl_add_u32 v19, v2, 3, v19
    v_add_u32 v19, s53, v19
    s_lshl_b32 s55, s44, 16
    s_lshl_b32 s51, s45, 7
    s_add_u32 s55, s55, s51
    v_mul_f32 v112, v0, v64
    v_mul_f32 v113, v0, v65
    v_mul_f32 v114, v0, v66
    v_mul_f32 v115, v0, v67
    v_mul_f32 v116, v0, v68
    v_mul_f32 v117, v0, v69
    v_mul_f32 v118, v0, v70
    v_mul_f32 v119, v0, v71
    v_exp_f32 v112, v112
    v_exp_f32 v113, v113
    v_mfma_f32_32x32x16_bf16 v[128:143], v[96:99], v[96:99], 0
    v_exp_f32 v114, v114
    v_exp_f32 v115, v115
    v_exp_f32 v116, v116
    v_exp_f32 v117, v117
    v_exp_f32 v118, v118
    v_exp_f32 v119, v119
    v_mul_f32 v64, v64, v72
    v_mul_f32 v65, v65, v73
    v_mul_f32 v66, v66, v74
    v_mul_f32 v67, v67, v75
    v_mfma_f32_32x32x16_bf16 v[144:159], v[96:99], v[96:99], 0
    v_mul_f32 v68, v68, v76
    v_mul_f32 v69, v69, v77
    v_mul_f32 v70, v70, v78
    v_mul_f32 v71, v71, v79
    v_fma_f32 v112, v112, v126, v126
    v_fma_f32 v113, v113, v126, v126
    v_fma_f32 v114, v114, v126, v126
    v_fma_f32 v115, v115, v126, v126
    v_fma_f32 v116, v116, v126, v126
    v_fma_f32 v117, v117, v126, v126
    v_mfma_f32_32x32x16_bf16 v[160:175], v[96:99], v[96:99], 0
    v_fma_f32 v118, v118, v126, v126
    v_fma_f32 v119, v119, v126, v126
    v_rcp_f32 v112, v112
    v_rcp_f32 v113, v113
    v_rcp_f32 v114, v114
    v_rcp_f32 v115, v115
    v_rcp_f32 v116, v116
    v_rcp_f32 v117, v117
    v_rcp_f32 v118, v118
    v_rcp_f32 v119, v119
    v_mfma_f32_32x32x16_bf16 v[176:191], v[96:99], v[96:99], 0
    v_mul_f32 v64, v64, v112
    v_mul_f32 v65, v65, v113
    v_mul_f32 v66, v66, v114
    v_mul_f32 v67, v67, v115
    v_mul_f32 v68, v68, v116
    v_mul_f32 v69, v69, v117
    v_mul_f32 v70, v70, v118
    v_mul_f32 v71, v71, v119
    v_cvt_pk_bf16_f32 v72, v64, v65
    v_cvt_pk_bf16_f32 v73, v66, v67
    v_cvt_pk_bf16_f32 v74, v68, v69
    v_cvt_pk_bf16_f32 v75, v70, v71
    buffer_store_dwordx4 v[72:75], v6, s[32:35], s73 offen offset:0 sc1
    v_mul_f32 v112, v0, v80
    v_mul_f32 v113, v0, v81
    v_mul_f32 v114, v0, v82
    v_mul_f32 v115, v0, v83
    v_mul_f32 v116, v0, v84
    v_mul_f32 v117, v0, v85
    v_mul_f32 v118, v0, v86
    v_mul_f32 v119, v0, v87
    v_exp_f32 v112, v112
    v_exp_f32 v113, v113
    v_exp_f32 v114, v114
    v_exp_f32 v115, v115
    v_exp_f32 v116, v116
    v_exp_f32 v117, v117
    v_exp_f32 v118, v118
    v_exp_f32 v119, v119
    v_mul_f32 v80, v80, v88
    v_mul_f32 v81, v81, v89
    v_mul_f32 v82, v82, v90
    v_mul_f32 v83, v83, v91
    v_mul_f32 v84, v84, v92
    v_mul_f32 v85, v85, v93
    v_mul_f32 v86, v86, v94
    v_mul_f32 v87, v87, v95
    v_fma_f32 v112, v112, v126, v126
    v_fma_f32 v113, v113, v126, v126
    v_fma_f32 v114, v114, v126, v126
    v_fma_f32 v115, v115, v126, v126
    v_fma_f32 v116, v116, v126, v126
    v_fma_f32 v117, v117, v126, v126
    v_fma_f32 v118, v118, v126, v126
    v_fma_f32 v119, v119, v126, v126
    s_waitcnt vmcnt(2)
    v_mfma_f32_32x32x16_bf16 v[192:207], v[224:227], v[24:27], 0
    v_rcp_f32 v112, v112
    v_rcp_f32 v113, v113
    v_rcp_f32 v114, v114
    v_rcp_f32 v115, v115
    v_mfma_f32_32x32x16_bf16 v[208:223], v[228:231], v[24:27], 0
    v_rcp_f32 v116, v116
    v_rcp_f32 v117, v117
    v_rcp_f32 v118, v118
    v_rcp_f32 v119, v119
    v_mul_f32 v80, v80, v112
    v_mul_f32 v81, v81, v113
    v_mul_f32 v82, v82, v114
    v_mul_f32 v83, v83, v115
    v_mul_f32 v84, v84, v116
    v_mul_f32 v85, v85, v117
    v_mul_f32 v86, v86, v118
    v_mul_f32 v87, v87, v119
    v_cvt_pk_bf16_f32 v88, v80, v81
    v_cvt_pk_bf16_f32 v89, v82, v83
    v_cvt_pk_bf16_f32 v90, v84, v85
    v_cvt_pk_bf16_f32 v91, v86, v87
    buffer_store_dwordx4 v[88:91], v6, s[32:35], s73 offen offset:1024 sc1
    v_max_f32 v2, v192, v193
    v_max3_f32 v2, v2, v194, v195
    v_max3_f32 v2, v2, v196, v197
    v_max3_f32 v2, v2, v198, v199
    v_max3_f32 v2, v2, v200, v201
    v_max3_f32 v2, v2, v202, v203
    v_max3_f32 v2, v2, v204, v205
    v_max3_f32 v2, v2, v206, v207
    v_max3_f32 v2, v2, v208, v209
    v_max3_f32 v2, v2, v210, v211
    v_max3_f32 v2, v2, v212, v213
    v_max3_f32 v2, v2, v214, v215
    v_max3_f32 v2, v2, v216, v217
    v_max3_f32 v2, v2, v218, v219
    v_max3_f32 v2, v2, v220, v221
    v_max3_f32 v2, v2, v222, v223
    v_mov_b32 v3, v2
    s_mov_b32 s60, 0
    s_nop 0
    v_permlane32_swap_b32 v2, v3
    s_nop 0
    v_max_f32 v2, v2, v3
    v_sub_f32 v240, 0xc2b40000, v2
    v_mov_b32 v241, v240
    v_mov_b32 v242, v240
    v_mov_b32 v243, v240
    v_mov_b32 v244, v240
    v_mov_b32 v245, v240
    v_mov_b32 v246, v240
    v_mov_b32 v247, v240
    v_mov_b32 v248, v240
    v_mov_b32 v249, v240
    v_mov_b32 v250, v240
    v_mov_b32 v251, v240
    v_mov_b32 v252, v240
    v_mov_b32 v253, v240
    v_mov_b32 v254, v240
    v_mov_b32 v255, v240
    s_nop 1
    v_mfma_f32_32x32x16_bf16 v[192:207], v[224:227], v[24:27], v[240:255]
    s_barrier
    s_setprio 3
    v_mfma_f32_32x32x16_bf16 v[224:239], v[96:99], v[96:99], 0
    s_setprio 0
    ds_read_b128 v[96:99], v6 offset:0
    ds_read_b128 v[100:103], v6 offset:1024
    ds_read_b128 v[104:107], v6 offset:2048
    ds_read_b128 v[108:111], v6 offset:3072
    s_mov_b64 exec, s[70:71]
    ds_read_b128 v[32:35], v6 offset:4096
    ds_read_b128 v[36:39], v6 offset:4352
    ds_read_b128 v[40:43], v6 offset:5120
    ds_read_b128 v[44:47], v6 offset:5376
    ds_read_b128 v[48:51], v6 offset:6144
    ds_read_b128 v[52:55], v6 offset:6400
    ds_read_b128 v[56:59], v6 offset:7168
    ds_read_b128 v[60:63], v6 offset:7424
    s_mov_b64 exec, -1
    s_cmp_lg_u32 s46, 4
    s_cbranch_scc1 L_ck13
    s_setprio 3
    s_mov_b64 exec, 0xfff
    s_waitcnt vmcnt(2)
L_ck13r_chk:
    v_cmp_ne_u32 vcc, s50, v16
    s_cmp_eq_u32 s66, 0
    s_cbranch_scc1 L_ck13r_ok
    s_nop 0
    s_cbranch_vccz L_ck13r_ok
    s_sub_u32 s66, s66, 1
    s_sleep 1
    buffer_load_dword v16, v125, s[32:35], s95 offen sc1
    s_waitcnt vmcnt(0)
    s_branch L_ck13r_chk
L_ck13r_ok:
    s_mov_b64 exec, -1
    s_setprio 0
L_ck13:
    s_add_u32 m0, s65, 16384
    s_nop 0
    buffer_load_dwordx4 v6, s[32:35], s61 offen sc1 lds
    s_add_u32 s61, s61, 4096
    s_add_u32 m0, s65, 24576
    s_nop 0
    buffer_load_dwordx4 v6, s[32:35], s61 offen sc1 lds
    s_add_u32 s61, s61, 4096
    s_add_u32 m0, s57, 49152
    s_nop 0
    buffer_load_dwordx4 v4, s[36:39], s63 offen lds
    buffer_load_dwordx4 v123, s[36:39], s63 offen offset:1024 lds
    s_add_u32 s63, s63, 131072
    s_waitcnt vmcnt(6)
    s_waitcnt lgkmcnt(0)
    s_cmp_eq_u32 s48, 2
    s_call_b64 s[78:79], L_burst
    s_add_u32 m0, s72, 49152
    s_nop 0
    buffer_load_dwordx4 v6, s[32:35], s80 offen sc1 lds
    buffer_load_dwordx4 v6, s[32:35], s89 offen offset:1024 sc1 lds
    s_add_u32 s80, s80, 8192
    s_add_u32 s89, s89, 8192
    ds_read_b128 v[96:99], v6 offset:8192
    ds_read_b128 v[100:103], v6 offset:9216
    ds_read_b128 v[104:107], v6 offset:10240
    ds_read_b128 v[108:111], v6 offset:11264
    s_mov_b64 exec, s[70:71]
    ds_read_b128 v[32:35], v6 offset:12288
    ds_read_b128 v[36:39], v6 offset:12544
    ds_read_b128 v[40:43], v6 offset:13312
    ds_read_b128 v[44:47], v6 offset:13568
    ds_read_b128 v[48:51], v6 offset:14336
    ds_read_b128 v[52:55], v6 offset:14592
    ds_read_b128 v[56:59], v6 offset:15360
    ds_read_b128 v[60:63], v6 offset:15616
    s_mov_b64 exec, -1
    s_add_u32 m0, s65, 0
    s_nop 0
    buffer_load_dwordx4 v6, s[32:35], s61 offen sc1 lds
    s_add_u32 s61, s61, 4096
    s_add_u32 m0, s72, 0
    s_nop 0
    buffer_load_dwordx4 v6, s[32:35], s80 offen sc1 lds
    buffer_load_dwordx4 v6, s[32:35], s89 offen offset:1024 sc1 lds
    s_add_u32 s80, s80, 8192
    s_add_u32 s89, s89, 8192
    s_add_u32 m0, s57, 0
    s_nop 0
    buffer_load_dwordx4 v4, s[36:39], s63 offen lds
    buffer_load_dwordx4 v123, s[36:39], s63 offen offset:1024 lds
    s_add_u32 s63, s63, 131072
    s_waitcnt vmcnt(11)
    s_waitcnt vmcnt(10)
    s_waitcnt lgkmcnt(0)
    s_cmp_eq_u32 s48, 2
    s_call_b64 s[78:79], L_burst
    ds_read_b128 v[96:99], v6 offset:16384
    ds_read_b128 v[100:103], v6 offset:17408
    ds_read_b128 v[104:107], v6 offset:18432
    ds_read_b128 v[108:111], v6 offset:19456
    s_mov_b64 exec, s[70:71]
    ds_read_b128 v[32:35], v6 offset:20480
    ds_read_b128 v[36:39], v6 offset:20736
    ds_read_b128 v[40:43], v6 offset:21504
    ds_read_b128 v[44:47], v6 offset:21760
    ds_read_b128 v[48:51], v6 offset:22528
    ds_read_b128 v[52:55], v6 offset:22784
    ds_read_b128 v[56:59], v6 offset:23552
    ds_read_b128 v[60:63], v6 offset:23808
    s_mov_b64 exec, -1
    s_cmp_lg_u32 s46, 0
    s_cbranch_scc1 L_fl14
    s_lshl4_add_u32 s94, s40, s41
    s_lshl_b32 s94, s94, 7
    s_add_u32 s94, s94, 21135360
    s_mov_b64 exec, 1
    buffer_store_dword v124, off, s[32:35], s94 sc1
    s_mov_b64 exec, -1
L_fl14:
    s_add_u32 m0, s65, 8192
    s_nop 0
    buffer_load_dwordx4 v6, s[32:35], s61 offen sc1 lds
    s_add_u32 s61, s61, 4096
    s_add_u32 m0, s72, 16384
    s_nop 0
    buffer_load_dwordx4 v6, s[32:35], s80 offen sc1 lds
    buffer_load_dwordx4 v6, s[32:35], s89 offen offset:1024 sc1 lds
    s_add_u32 s80, s80, 8192
    s_add_u32 s89, s89, 8192
    s_add_u32 m0, s57, 16384
    s_nop 0
    buffer_load_dwordx4 v4, s[36:39], s63 offen lds
    buffer_load_dwordx4 v123, s[36:39], s63 offen offset:1024 lds
    s_add_u32 s63, s63, 131072
    s_waitcnt lgkmcnt(0)
    s_cmp_eq_u32 s48, 2
    s_call_b64 s[78:79], L_burst
    ds_read_b128 v[96:99], v6 offset:24576
    ds_read_b128 v[100:103], v6 offset:25600
    ds_read_b128 v[104:107], v6 offset:26624
    ds_read_b128 v[108:111], v6 offset:27648
    s_mov_b64 exec, s[70:71]
    ds_read_b128 v[32:35], v6 offset:28672
    ds_read_b128 v[36:39], v6 offset:28928
    ds_read_b128 v[40:43], v6 offset:29696
    ds_read_b128 v[44:47], v6 offset:29952
    ds_read_b128 v[48:51], v6 offset:30720
    ds_read_b128 v[52:55], v6 offset:30976
    ds_read_b128 v[56:59], v6 offset:31744
    ds_read_b128 v[60:63], v6 offset:32000
    s_mov_b64 exec, -1
    ds_read_b64_tr_b16 v[144:145], v1 offset:49152
    ds_read_b64_tr_b16 v[146:147], v1 offset:50176
    ds_read_b128 v[160:163], v122 offset:49152
    ds_read_b64_tr_b16 v[148:149], v1 offset:51200
    ds_read_b64_tr_b16 v[150:151], v1 offset:52224
    ds_read_b128 v[164:167], v122 offset:51200
    ds_read_b64_tr_b16 v[152:153], v1 offset:53248
    ds_read_b64_tr_b16 v[154:155], v1 offset:54272
    ds_read_b128 v[168:171], v122 offset:53248
    ds_read_b64_tr_b16 v[156:157], v1 offset:55296
    ds_read_b64_tr_b16 v[158:159], v1 offset:56320
    ds_read_b128 v[172:175], v122 offset:55296
    s_add_u32 m0, s65, 16384
    s_nop 0
    buffer_load_dwordx4 v6, s[32:35], s61 offen sc1 lds
    s_add_u32 s61, s61, 4096
    s_add_u32 m0, s72, 32768
    s_nop 0
    buffer_load_dwordx4 v6, s[32:35], s80 offen sc1 lds
    buffer_load_dwordx4 v6, s[32:35], s89 offen offset:1024 sc1 lds
    s_add_u32 s80, s80, 8192
    s_add_u32 s89, s89, 8192
    s_add_u32 m0, s57, 32768
    s_nop 0
    buffer_load_dwordx4 v4, s[36:39], s63 offen lds
    buffer_load_dwordx4 v123, s[36:39], s63 offen offset:1024 lds
    s_add_u32 s63, s63, 131072
    s_waitcnt lgkmcnt(0)
    s_cmp_eq_u32 s48, 2
    s_call_b64 s[78:79], L_burst
    ds_read_b128 v[96:99], v6 offset:0
    ds_read_b128 v[100:103], v6 offset:1024
    ds_read_b128 v[104:107], v6 offset:2048
    ds_read_b128 v[108:111], v6 offset:3072
    s_mov_b64 exec, s[70:71]
    ds_read_b128 v[32:35], v6 offset:4096
    ds_read_b128 v[36:39], v6 offset:4352
    ds_read_b128 v[40:43], v6 offset:5120
    ds_read_b128 v[44:47], v6 offset:5376
    ds_read_b128 v[48:51], v6 offset:6144
    ds_read_b128 v[52:55], v6 offset:6400
    ds_read_b128 v[56:59], v6 offset:7168
    ds_read_b128 v[60:63], v6 offset:7424
    s_mov_b64 exec, -1
    ds_read_b64_tr_b16 v[144:145], v1 offset:0
    ds_read_b64_tr_b16 v[146:147], v1 offset:1024
    ds_read_b128 v[160:163], v122 offset:0
    ds_read_b64_tr_b16 v[148:149], v1 offset:2048
    ds_read_b64_tr_b16 v[150:151], v1 offset:3072
    ds_read_b128 v[164:167], v122 offset:2048
    ds_read_b64_tr_b16 v[152:153], v1 offset:4096
    ds_read_b64_tr_b16 v[154:155], v1 offset:5120
    ds_read_b128 v[168:171], v122 offset:4096
    ds_read_b64_tr_b16 v[156:157], v1 offset:6144
    ds_read_b64_tr_b16 v[158:159], v1 offset:7168
    ds_read_b128 v[172:175], v122 offset:6144
    s_cmp_lg_u32 s46, 4
    s_cbranch_scc1 L_fl15
    s_mov_b64 exec, 0xffff
    buffer_load_dword v16, v125, s[32:35], s96 offen sc1
    s_mov_b64 exec, -1
L_fl15:
    s_add_u32 m0, s65, 24576
    s_nop 0
    buffer_load_dwordx4 v6, s[32:35], s61 offen sc1 lds
    s_add_u32 s61, s61, 4096
    s_add_u32 m0, s72, 49152
    s_nop 0
    buffer_load_dwordx4 v6, s[32:35], s80 offen sc1 lds
    buffer_load_dwordx4 v6, s[32:35], s89 offen offset:1024 sc1 lds
    s_add_u32 s80, s80, 8192
    s_add_u32 s89, s89, 8192
    s_add_u32 m0, s57, 49152
    s_nop 0
    buffer_load_dwordx4 v4, s[36:39], s63 offen lds
    buffer_load_dwordx4 v123, s[36:39], s63 offen offset:1024 lds
    s_add_u32 s63, s63, 131072
    s_waitcnt lgkmcnt(0)
    s_cmp_eq_u32 s48, 2
    s_call_b64 s[78:79], L_burst
    ds_read_b128 v[96:99], v6 offset:8192
    ds_read_b128 v[100:103], v6 offset:9216
    ds_read_b128 v[104:107], v6 offset:10240
    ds_read_b128 v[108:111], v6 offset:11264
    s_mov_b64 exec, s[70:71]
    ds_read_b128 v[32:35], v6 offset:12288
    ds_read_b128 v[36:39], v6 offset:12544
    ds_read_b128 v[40:43], v6 offset:13312
    ds_read_b128 v[44:47], v6 offset:13568
    ds_read_b128 v[48:51], v6 offset:14336
    ds_read_b128 v[52:55], v6 offset:14592
    ds_read_b128 v[56:59], v6 offset:15360
    ds_read_b128 v[60:63], v6 offset:15616
    s_mov_b64 exec, -1
    ds_read_b64_tr_b16 v[144:145], v1 offset:16384
    ds_read_b64_tr_b16 v[146:147], v1 offset:17408
    ds_read_b128 v[160:163], v122 offset:16384
    ds_read_b64_tr_b16 v[148:149], v1 offset:18432
    ds_read_b64_tr_b16 v[150:151], v1 offset:19456
    ds_read_b128 v[164:167], v122 offset:18432
    ds_read_b64_tr_b16 v[152:153], v1 offset:20480
    ds_read_b64_tr_b16 v[154:155], v1 offset:21504
    ds_read_b128 v[168:171], v122 offset:20480
    ds_read_b64_tr_b16 v[156:157], v1 offset:22528
    ds_read_b64_tr_b16 v[158:159], v1 offset:23552
    ds_read_b128 v[172:175], v122 offset:22528
    s_cmp_lg_u32 s46, 4
    s_cbranch_scc1 L_ck16
    s_setprio 3
    s_mov_b64 exec, 0xffff
    s_waitcnt vmcnt(5)
L_ck16r_chk:
    v_cmp_ne_u32 vcc, s50, v16
    s_cmp_eq_u32 s66, 0
    s_cbranch_scc1 L_ck16r_ok
    s_nop 0
    s_cbranch_vccz L_ck16r_ok
    s_sub_u32 s66, s66, 1
    s_sleep 1
    buffer_load_dword v16, v125, s[32:35], s96 offen sc1
    s_waitcnt vmcnt(0)
    s_branch L_ck16r_chk
L_ck16r_ok:
    s_mov_b64 exec, -1
    s_setprio 0
L_ck16:
    s_add_u32 m0, s65, 0
    s_nop 0
    buffer_load_dwordx4 v6, s[32:35], s61 offen sc1 lds
    s_add_u32 s61, s61, 4096
    s_add_u32 m0, s72, 0
    s_nop 0
    buffer_load_dwordx4 v6, s[32:35], s80 offen sc1 lds
    buffer_load_dwordx4 v6, s[32:35], s89 offen offset:1024 sc1 lds
    s_add_u32 s80, s80, 8192
    s_add_u32 s89, s89, 8192
    s_add_u32 m0, s57, 0
    s_nop 0
    buffer_load_dwordx4 v4, s[36:39], s63 offen lds
    buffer_load_dwordx4 v123, s[36:39], s63 offen offset:1024 lds
    s_add_u32 s63, s63, 131072
    s_waitcnt lgkmcnt(0)
    s_cmp_eq_u32 s48, 2
    s_call_b64 s[78:79], L_burst
    ds_read_b128 v[96:99], v6 offset:16384
    ds_read_b128 v[100:103], v6 offset:17408
    ds_read_b128 v[104:107], v6 offset:18432
    ds_read_b128 v[108:111], v6 offset:19456
    s_mov_b64 exec, s[70:71]
    ds_read_b128 v[32:35], v6 offset:20480
    ds_read_b128 v[36:39], v6 offset:20736
    ds_read_b128 v[40:43], v6 offset:21504
    ds_read_b128 v[44:47], v6 offset:21760
    ds_read_b128 v[48:51], v6 offset:22528
    ds_read_b128 v[52:55], v6 offset:22784
    ds_read_b128 v[56:59], v6 offset:23552
    ds_read_b128 v[60:63], v6 offset:23808
    s_mov_b64 exec, -1
    ds_read_b64_tr_b16 v[144:145], v1 offset:32768
    ds_read_b64_tr_b16 v[146:147], v1 offset:33792
    ds_read_b128 v[160:163], v122 offset:32768
    ds_read_b64_tr_b16 v[148:149], v1 offset:34816
    ds_read_b64_tr_b16 v[150:151], v1 offset:35840
    ds_read_b128 v[164:167], v122 offset:34816
    ds_read_b64_tr_b16 v[152:153], v1 offset:36864
    ds_read_b64_tr_b16 v[154:155], v1 offset:37888
    ds_read_b128 v[168:171], v122 offset:36864
    ds_read_b64_tr_b16 v[156:157], v1 offset:38912
    ds_read_b64_tr_b16 v[158:159], v1 offset:39936
    ds_read_b128 v[172:175], v122 offset:38912
    s_add_u32 m0, s65, 8192
    s_nop 0
    buffer_load_dwordx4 v6, s[32:35], s61 offen sc1 lds
    s_add_u32 s61, s61, 4096
    s_add_u32 m0, s72, 16384
    s_nop 0
    buffer_load_dwordx4 v6, s[32:35], s80 offen sc1 lds
    buffer_load_dwordx4 v6, s[32:35], s89 offen offset:1024 sc1 lds
    s_add_u32 s80, s80, 8192
    s_add_u32 s89, s89, 8192
    s_add_u32 m0, s57, 16384
    s_nop 0
    buffer_load_dwordx4 v4, s[36:39], s63 offen lds
    buffer_load_dwordx4 v123, s[36:39], s63 offen offset:1024 lds
    s_add_u32 s63, s63, 131072
    s_waitcnt lgkmcnt(0)
    s_cmp_eq_u32 s48, 2
    s_call_b64 s[78:79], L_burst
    ds_read_b128 v[96:99], v6 offset:24576
    ds_read_b128 v[100:103], v6 offset:25600
    ds_read_b128 v[104:107], v6 offset:26624
    ds_read_b128 v[108:111], v6 offset:27648
    s_mov_b64 exec, s[70:71]
    ds_read_b128 v[32:35], v6 offset:28672
    ds_read_b128 v[36:39], v6 offset:28928
    ds_read_b128 v[40:43], v6 offset:29696
    ds_read_b128 v[44:47], v6 offset:29952
    ds_read_b128 v[48:51], v6 offset:30720
    ds_read_b128 v[52:55], v6 offset:30976
    ds_read_b128 v[56:59], v6 offset:31744
    ds_read_b128 v[60:63], v6 offset:32000
    s_mov_b64 exec, -1
    ds_read_b64_tr_b16 v[144:145], v1 offset:49152
    ds_read_b64_tr_b16 v[146:147], v1 offset:50176
    ds_read_b128 v[160:163], v122 offset:49152
    ds_read_b64_tr_b16 v[148:149], v1 offset:51200
    ds_read_b64_tr_b16 v[150:151], v1 offset:52224
    ds_read_b128 v[164:167], v122 offset:51200
    ds_read_b64_tr_b16 v[152:153], v1 offset:53248
    ds_read_b64_tr_b16 v[154:155], v1 offset:54272
    ds_read_b128 v[168:171], v122 offset:53248
    ds_read_b64_tr_b16 v[156:157], v1 offset:55296
    ds_read_b64_tr_b16 v[158:159], v1 offset:56320
    ds_read_b128 v[172:175], v122 offset:55296
    s_add_u32 m0, s65, 16384
    s_nop 0
    buffer_load_dwordx4 v6, s[32:35], s61 offen sc1 lds
    s_add_u32 s61, s61, 4096
    s_add_u32 m0, s72, 32768
    s_nop 0
    buffer_load_dwordx4 v6, s[32:35], s80 offen sc1 lds
    buffer_load_dwordx4 v6, s[32:35], s89 offen offset:1024 sc1 lds
    s_add_u32 s80, s80, 8192
    s_add_u32 s89, s89, 8192
    s_add_u32 m0, s57, 32768
    s_nop 0
    buffer_load_dwordx4 v4, s[36:39], s63 offen lds
    buffer_load_dwordx4 v123, s[36:39], s63 offen offset:1024 lds
    s_add_u32 s63, s63, 131072
    s_waitcnt lgkmcnt(0)
    s_cmp_eq_u32 s48, 2
    s_call_b64 s[78:79], L_burst
    ds_read_b128 v[96:99], v6 offset:0
    ds_read_b128 v[100:103], v6 offset:1024
    ds_read_b128 v[104:107], v6 offset:2048
    ds_read_b128 v[108:111], v6 offset:3072
    s_mov_b64 exec, s[70:71]
    ds_read_b128 v[32:35], v6 offset:4096
    ds_read_b128 v[36:39], v6 offset:4352
    ds_read_b128 v[40:43], v6 offset:5120
    ds_read_b128 v[44:47], v6 offset:5376
    ds_read_b128 v[48:51], v6 offset:6144
    ds_read_b128 v[52:55], v6 offset:6400
    ds_read_b128 v[56:59], v6 offset:7168
    ds_read_b128 v[60:63], v6 offset:7424
    s_mov_b64 exec, -1
    ds_read_b64_tr_b16 v[144:145], v1 offset:0
    ds_read_b64_tr_b16 v[146:147], v1 offset:1024
    ds_read_b128 v[160:163], v122 offset:0
    ds_read_b64_tr_b16 v[148:149], v1 offset:2048
    ds_read_b64_tr_b16 v[150:151], v1 offset:3072
    ds_read_b128 v[164:167], v122 offset:2048
    ds_read_b64_tr_b16 v[152:153], v1 offset:4096
    ds_read_b64_tr_b16 v[154:155], v1 offset:5120
    ds_read_b128 v[168:171], v122 offset:4096
    ds_read_b64_tr_b16 v[156:157], v1 offset:6144
    ds_read_b64_tr_b16 v[158:159], v1 offset:7168
    ds_read_b128 v[172:175], v122 offset:6144
    s_add_u32 m0, s65, 24576
    s_nop 0
    buffer_load_dwordx4 v6, s[32:35], s61 offen sc1 lds
    s_add_u32 s61, s61, 4096
    s_add_u32 m0, s72, 49152
    s_nop 0
    buffer_load_dwordx4 v6, s[32:35], s80 offen sc1 lds
    buffer_load_dwordx4 v6, s[32:35], s89 offen offset:1024 sc1 lds
    s_add_u32 s80, s80, 8192
    s_add_u32 s89, s89, 8192
    s_add_u32 m0, s57, 49152
    s_nop 0
    buffer_load_dwordx4 v4, s[36:39], s63 offen lds
    buffer_load_dwordx4 v123, s[36:39], s63 offen offset:1024 lds
    s_add_u32 s63, s63, 131072
    s_waitcnt lgkmcnt(0)
    s_cmp_eq_u32 s48, 2
    s_call_b64 s[78:79], L_burst
    ds_read_b128 v[96:99], v6 offset:8192
    ds_read_b128 v[100:103], v6 offset:9216
    ds_read_b128 v[104:107], v6 offset:10240
    ds_read_b128 v[108:111], v6 offset:11264
    s_mov_b64 exec, s[70:71]
    ds_read_b128 v[32:35], v6 offset:12288
    ds_read_b128 v[36:39], v6 offset:12544
    ds_read_b128 v[40:43], v6 offset:13312
    ds_read_b128 v[44:47], v6 offset:13568
    ds_read_b128 v[48:51], v6 offset:14336
    ds_read_b128 v[52:55], v6 offset:14592
    ds_read_b128 v[56:59], v6 offset:15360
    ds_read_b128 v[60:63], v6 offset:15616
    s_mov_b64 exec, -1
    ds_read_b64_tr_b16 v[144:145], v1 offset:16384
    ds_read_b64_tr_b16 v[146:147], v1 offset:17408
    ds_read_b128 v[160:163], v122 offset:16384
    ds_read_b64_tr_b16 v[148:149], v1 offset:18432
    ds_read_b64_tr_b16 v[150:151], v1 offset:19456
    ds_read_b128 v[164:167], v122 offset:18432
    ds_read_b64_tr_b16 v[152:153], v1 offset:20480
    ds_read_b64_tr_b16 v[154:155], v1 offset:21504
    ds_read_b128 v[168:171], v122 offset:20480
    ds_read_b64_tr_b16 v[156:157], v1 offset:22528
    ds_read_b64_tr_b16 v[158:159], v1 offset:23552
    ds_read_b128 v[172:175], v122 offset:22528
    s_add_u32 m0, s65, 0
    s_nop 0
    buffer_load_dwordx4 v6, s[32:35], s61 offen sc1 lds
    s_add_u32 s61, s61, 4096
    s_add_u32 m0, s72, 0
    s_nop 0
    buffer_load_dwordx4 v6, s[32:35], s80 offen sc1 lds
    buffer_load_dwordx4 v6, s[32:35], s89 offen offset:1024 sc1 lds
    s_add_u32 s80, s80, 8192
    s_add_u32 s89, s89, 8192
    s_add_u32 m0, s57, 0
    s_nop 0
    buffer_load_dwordx4 v4, s[36:39], s63 offen lds
    buffer_load_dwordx4 v123, s[36:39], s63 offen offset:1024 lds
    s_add_u32 s63, s63, 131072
    s_waitcnt lgkmcnt(0)
    s_cmp_eq_u32 s48, 2
    s_call_b64 s[78:79], L_burst
    ds_read_b128 v[96:99], v6 offset:16384
    ds_read_b128 v[100:103], v6 offset:17408
    ds_read_b128 v[104:107], v6 offset:18432
    ds_read_b128 v[108:111], v6 offset:19456
    s_mov_b64 exec, s[70:71]
    ds_read_b128 v[32:35], v6 offset:20480
    ds_read_b128 v[36:39], v6 offset:20736
    ds_read_b128 v[40:43], v6 offset:21504
    ds_read_b128 v[44:47], v6 offset:21760
    ds_read_b128 v[48:51], v6 offset:22528
    ds_read_b128 v[52:55], v6 offset:22784
    ds_read_b128 v[56:59], v6 offset:23552
    ds_read_b128 v[60:63], v6 offset:23808
    s_mov_b64 exec, -1
    ds_read_b64_tr_b16 v[144:145], v1 offset:32768
    ds_read_b64_tr_b16 v[146:147], v1 offset:33792
    ds_read_b128 v[160:163], v122 offset:32768
    ds_read_b64_tr_b16 v[148:149], v1 offset:34816
    ds_read_b64_tr_b16 v[150:151], v1 offset:35840
    ds_read_b128 v[164:167], v122 offset:34816
    ds_read_b64_tr_b16 v[152:153], v1 offset:36864
    ds_read_b64_tr_b16 v[154:155], v1 offset:37888
    ds_read_b128 v[168:171], v122 offset:36864
    ds_read_b64_tr_b16 v[156:157], v1 offset:38912
    ds_read_b64_tr_b16 v[158:159], v1 offset:39936
    ds_read_b128 v[172:175], v122 offset:38912
    s_add_u32 m0, s65, 8192
    s_nop 0
    buffer_load_dwordx4 v6, s[32:35], s61 offen sc1 lds
    s_add_u32 s61, s61, 4096
    s_add_u32 m0, s72, 16384
    s_nop 0
    buffer_load_dwordx4 v6, s[32:35], s80 offen sc1 lds
    buffer_load_dwordx4 v6, s[32:35], s89 offen offset:1024 sc1 lds
    s_add_u32 s80, s80, 8192
    s_add_u32 s89, s89, 8192
    s_add_u32 m0, s57, 16384
    s_nop 0
    buffer_load_dwordx4 v4, s[36:39], s63 offen lds
    buffer_load_dwordx4 v123, s[36:39], s63 offen offset:1024 lds
    s_add_u32 s63, s63, 131072
    s_waitcnt lgkmcnt(0)
    s_cmp_eq_u32 s48, 2
    s_call_b64 s[78:79], L_burst
    ds_read_b128 v[96:99], v6 offset:24576
    ds_read_b128 v[100:103], v6 offset:25600
    ds_read_b128 v[104:107], v6 offset:26624
    ds_read_b128 v[108:111], v6 offset:27648
    s_mov_b64 exec, s[70:71]
    ds_read_b128 v[32:35], v6 offset:28672
    ds_read_b128 v[36:39], v6 offset:28928
    ds_read_b128 v[40:43], v6 offset:29696
    ds_read_b128 v[44:47], v6 offset:29952
    ds_read_b128 v[48:51], v6 offset:30720
    ds_read_b128 v[52:55], v6 offset:30976
    ds_read_b128 v[56:59], v6 offset:31744
    ds_read_b128 v[60:63], v6 offset:32000
    s_mov_b64 exec, -1
    ds_read_b64_tr_b16 v[144:145], v1 offset:49152
    ds_read_b64_tr_b16 v[146:147], v1 offset:50176
    ds_read_b128 v[160:163], v122 offset:49152
    ds_read_b64_tr_b16 v[148:149], v1 offset:51200
    ds_read_b64_tr_b16 v[150:151], v1 offset:52224
    ds_read_b128 v[164:167], v122 offset:51200
    ds_read_b64_tr_b16 v[152:153], v1 offset:53248
    ds_read_b64_tr_b16 v[154:155], v1 offset:54272
    ds_read_b128 v[168:171], v122 offset:53248
    ds_read_b64_tr_b16 v[156:157], v1 offset:55296
    ds_read_b64_tr_b16 v[158:159], v1 offset:56320
    ds_read_b128 v[172:175], v122 offset:55296
    s_add_u32 m0, s65, 16384
    s_nop 0
    buffer_load_dwordx4 v6, s[32:35], s61 offen sc1 lds
    s_add_u32 s61, s61, 4096
    s_add_u32 m0, s72, 32768
    s_nop 0
    buffer_load_dwordx4 v6, s[32:35], s80 offen sc1 lds
    buffer_load_dwordx4 v6, s[32:35], s89 offen offset:1024 sc1 lds
    s_add_u32 s80, s80, 8192
    s_add_u32 s89, s89, 8192
    s_add_u32 m0, s57, 32768
    s_nop 0
    buffer_load_dwordx4 v4, s[36:39], s63 offen lds
    buffer_load_dwordx4 v123, s[36:39], s63 offen offset:1024 lds
    s_add_u32 s63, s63, 131072
    s_waitcnt lgkmcnt(0)
    s_cmp_eq_u32 s48, 2
    s_call_b64 s[78:79], L_burst
    ds_read_b128 v[96:99], v6 offset:0
    ds_read_b128 v[100:103], v6 offset:1024
    ds_read_b128 v[104:107], v6 offset:2048
    ds_read_b128 v[108:111], v6 offset:3072
    s_mov_b64 exec, s[70:71]
    ds_read_b128 v[32:35], v6 offset:4096
    ds_read_b128 v[36:39], v6 offset:4352
    ds_read_b128 v[40:43], v6 offset:5120
    ds_read_b128 v[44:47], v6 offset:5376
    ds_read_b128 v[48:51], v6 offset:6144
    ds_read_b128 v[52:55], v6 offset:6400
    ds_read_b128 v[56:59], v6 offset:7168
    ds_read_b128 v[60:63], v6 offset:7424
    s_mov_b64 exec, -1
    ds_read_b64_tr_b16 v[144:145], v1 offset:0
    ds_read_b64_tr_b16 v[146:147], v1 offset:1024
    ds_read_b128 v[160:163], v122 offset:0
    ds_read_b64_tr_b16 v[148:149], v1 offset:2048
    ds_read_b64_tr_b16 v[150:151], v1 offset:3072
    ds_read_b128 v[164:167], v122 offset:2048
    ds_read_b64_tr_b16 v[152:153], v1 offset:4096
    ds_read_b64_tr_b16 v[154:155], v1 offset:5120
    ds_read_b128 v[168:171], v122 offset:4096
    ds_read_b64_tr_b16 v[156:157], v1 offset:6144
    ds_read_b64_tr_b16 v[158:159], v1 offset:7168
    ds_read_b128 v[172:175], v122 offset:6144
    s_add_u32 m0, s65, 24576
    s_nop 0
    buffer_load_dwordx4 v6, s[32:35], s61 offen sc1 lds
    s_add_u32 s61, s61, 4096
    s_add_u32 m0, s72, 49152
    s_nop 0
    buffer_load_dwordx4 v6, s[32:35], s80 offen sc1 lds
    buffer_load_dwordx4 v6, s[32:35], s89 offen offset:1024 sc1 lds
    s_add_u32 s80, s80, 8192
    s_add_u32 s89, s89, 8192
    s_add_u32 m0, s57, 49152
    s_nop 0
    buffer_load_dwordx4 v4, s[36:39], s63 offen lds
    buffer_load_dwordx4 v123, s[36:39], s63 offen offset:1024 lds
    s_add_u32 s63, s63, 131072
    s_waitcnt lgkmcnt(0)
    s_cmp_eq_u32 s48, 2
    s_call_b64 s[78:79], L_burst
    ds_read_b128 v[96:99], v6 offset:8192
    ds_read_b128 v[100:103], v6 offset:9216
    ds_read_b128 v[104:107], v6 offset:10240
    ds_read_b128 v[108:111], v6 offset:11264
    s_mov_b64 exec, s[70:71]
    ds_read_b128 v[32:35], v6 offset:12288
    ds_read_b128 v[36:39], v6 offset:12544
    ds_read_b128 v[40:43], v6 offset:13312
    ds_read_b128 v[44:47], v6 offset:13568
    ds_read_b128 v[48:51], v6 offset:14336
    ds_read_b128 v[52:55], v6 offset:14592
    ds_read_b128 v[56:59], v6 offset:15360
    ds_read_b128 v[60:63], v6 offset:15616
    s_mov_b64 exec, -1
    ds_read_b64_tr_b16 v[144:145], v1 offset:16384
    ds_read_b64_tr_b16 v[146:147], v1 offset:17408
    ds_read_b128 v[160:163], v122 offset:16384
    ds_read_b64_tr_b16 v[148:149], v1 offset:18432
    ds_read_b64_tr_b16 v[150:151], v1 offset:19456
    ds_read_b128 v[164:167], v122 offset:18432
    ds_read_b64_tr_b16 v[152:153], v1 offset:20480
    ds_read_b64_tr_b16 v[154:155], v1 offset:21504
    ds_read_b128 v[168:171], v122 offset:20480
    ds_read_b64_tr_b16 v[156:157], v1 offset:22528
    ds_read_b64_tr_b16 v[158:159], v1 offset:23552
    ds_read_b128 v[172:175], v122 offset:22528
    s_add_u32 m0, s65, 0
    s_nop 0
    buffer_load_dwordx4 v6, s[32:35], s61 offen sc1 lds
    s_add_u32 s61, s61, 4096
    s_add_u32 m0, s72, 0
    s_nop 0
    buffer_load_dwordx4 v6, s[32:35], s80 offen sc1 lds
    buffer_load_dwordx4 v6, s[32:35], s89 offen offset:1024 sc1 lds
    s_add_u32 s80, s80, 8192
    s_add_u32 s89, s89, 8192
    s_add_u32 m0, s57, 0
    s_nop 0
    buffer_load_dwordx4 v4, s[36:39], s63 offen lds
    buffer_load_dwordx4 v123, s[36:39], s63 offen offset:1024 lds
    s_add_u32 s63, s63, 131072
    buffer_load_dwordx4 v[28:31], v19, s[4:7], s55 offen
    s_waitcnt lgkmcnt(0)
    s_cmp_eq_u32 s48, 2
    s_call_b64 s[78:79], L_burst
    ds_read_b128 v[96:99], v6 offset:16384
    ds_read_b128 v[100:103], v6 offset:17408
    ds_read_b128 v[104:107], v6 offset:18432
    ds_read_b128 v[108:111], v6 offset:19456
    s_mov_b64 exec, s[70:71]
    ds_read_b128 v[32:35], v6 offset:20480
    ds_read_b128 v[36:39], v6 offset:20736
    ds_read_b128 v[40:43], v6 offset:21504
    ds_read_b128 v[44:47], v6 offset:21760
    ds_read_b128 v[48:51], v6 offset:22528
    ds_read_b128 v[52:55], v6 offset:22784
    ds_read_b128 v[56:59], v6 offset:23552
    ds_read_b128 v[60:63], v6 offset:23808
    s_mov_b64 exec, -1
    ds_read_b64_tr_b16 v[144:145], v1 offset:32768
    ds_read_b64_tr_b16 v[146:147], v1 offset:33792
    ds_read_b128 v[160:163], v122 offset:32768
    ds_read_b64_tr_b16 v[148:149], v1 offset:34816
    ds_read_b64_tr_b16 v[150:151], v1 offset:35840
    ds_read_b128 v[164:167], v122 offset:34816
    ds_read_b64_tr_b16 v[152:153], v1 offset:36864
    ds_read_b64_tr_b16 v[154:155], v1 offset:37888
    ds_read_b128 v[168:171], v122 offset:36864
    ds_read_b64_tr_b16 v[156:157], v1 offset:38912
    ds_read_b64_tr_b16 v[158:159], v1 offset:39936
    ds_read_b128 v[172:175], v122 offset:38912
    s_mov_b32 s36, s24
    s_mov_b32 s37, s25
    s_mov_b32 s38, s26
    s_mov_b32 s39, s27
    s_lshl_b32 s63, s46, 14
    s_lshl_b32 s53, s45, 7
    s_add_u32 s63, s63, s53
    s_add_u32 m0, s57, 16384
    s_nop 0
    buffer_load_dwordx4 v4, s[36:39], s63 offen lds
    buffer_load_dwordx4 v123, s[36:39], s63 offen offset:1024 lds
    s_add_u32 s63, s63, 131072
    s_add_u32 m0, s72, 16384
    s_add_u32 s51, s63, 131072
    buffer_load_dwordx4 v4, s[36:39], s51 offen lds
    buffer_load_dwordx4 v123, s[36:39], s51 offen offset:1024 lds
    s_waitcnt lgkmcnt(0)
    s_cmp_eq_u32 s48, 2
    s_call_b64 s[78:79], L_burst
    ds_read_b128 v[96:99], v6 offset:24576
    ds_read_b128 v[100:103], v6 offset:25600
    ds_read_b128 v[104:107], v6 offset:26624
    ds_read_b128 v[108:111], v6 offset:27648
    s_mov_b64 exec, s[70:71]
    ds_read_b128 v[32:35], v6 offset:28672
    ds_read_b128 v[36:39], v6 offset:28928
    ds_read_b128 v[40:43], v6 offset:29696
    ds_read_b128 v[44:47], v6 offset:29952
    ds_read_b128 v[48:51], v6 offset:30720
    ds_read_b128 v[52:55], v6 offset:30976
    ds_read_b128 v[56:59], v6 offset:31744
    ds_read_b128 v[60:63], v6 offset:32000
    s_mov_b64 exec, -1
    ds_read_b64_tr_b16 v[144:145], v1 offset:49152
    ds_read_b64_tr_b16 v[146:147], v1 offset:50176
    ds_read_b128 v[160:163], v122 offset:49152
    ds_read_b64_tr_b16 v[148:149], v1 offset:51200
    ds_read_b64_tr_b16 v[150:151], v1 offset:52224
    ds_read_b128 v[164:167], v122 offset:51200
    ds_read_b64_tr_b16 v[152:153], v1 offset:53248
    ds_read_b64_tr_b16 v[154:155], v1 offset:54272
    ds_read_b128 v[168:171], v122 offset:53248
    ds_read_b64_tr_b16 v[156:157], v1 offset:55296
    ds_read_b64_tr_b16 v[158:159], v1 offset:56320
    ds_read_b128 v[172:175], v122 offset:55296
    s_add_u32 m0, s57, 32768
    s_nop 0
    buffer_load_dwordx4 v4, s[36:39], s63 offen lds
    buffer_load_dwordx4 v123, s[36:39], s63 offen offset:1024 lds
    s_add_u32 s63, s63, 131072
    s_add_u32 m0, s72, 32768
    s_add_u32 s51, s63, 131072
    buffer_load_dwordx4 v4, s[36:39], s51 offen lds
    buffer_load_dwordx4 v123, s[36:39], s51 offen offset:1024 lds
    s_setprio 3
    v_mov_b32 v88, v32
    v_mov_b32 v89, v32
    v_mov_b32 v90, v32
    v_mov_b32 v91, v32
    v_mov_b32 v92, v32
    v_mov_b32 v93, v32
    v_mov_b32 v94, v32
    v_mov_b32 v95, v32
    s_setprio 0
    s_mov_b64 exec, s[70:71]
    ds_read_b128 v[88:91], v6 offset:4096
    ds_read_b128 v[92:95], v6 offset:4352
    s_mov_b64 exec, -1
    s_waitcnt lgkmcnt(0)
    s_cmp_eq_u32 s48, 1
    s_call_b64 s[78:79], L_burst
    s_setprio 1
    v_mfma_f32_32x32x16_bf16 v[224:239], v[88:91], v[184:187], v[224:239]
    v_mfma_f32_32x32x16_bf16 v[224:239], v[92:95], v[188:191], v[224:239]
    ds_read_b64_tr_b16 v[144:145], v1 offset:0
    ds_read_b64_tr_b16 v[146:147], v1 offset:1024
    ds_read_b128 v[160:163], v122 offset:0
    ds_read_b64_tr_b16 v[148:149], v1 offset:2048
    ds_read_b64_tr_b16 v[150:151], v1 offset:3072
    ds_read_b128 v[164:167], v122 offset:2048
    ds_read_b64_tr_b16 v[152:153], v1 offset:4096
    ds_read_b64_tr_b16 v[154:155], v1 offset:5120
    ds_read_b128 v[168:171], v122 offset:4096
    ds_read_b64_tr_b16 v[156:157], v1 offset:6144
    ds_read_b64_tr_b16 v[158:159], v1 offset:7168
    ds_read_b128 v[172:175], v122 offset:6144
    s_mul_i32 s51, s82, 144
    s_add_u32 s51, s51, s42
    s_lshl_b32 s51, s51, 10
    s_add_u32 s51, s51, 8503296
    s_bfe_u32 s52, s46, 0x10001
    s_lshl1_add_u32 s52, s44, s52
    s_mul_i32 s80, s52, 147456
    s_and_b32 s53, s46, 1
    v_mov_b32 v3, 0x7a800000
    s_mov_b32 s81, 0
    v_rcp_f32 v5, v232
    v_mov_b32 v2, v232
    v_fma_f32 v2, v224, 0, v2
    v_fma_f32 v2, v225, 0, v2
    v_fma_f32 v2, v226, 0, v2
    v_fma_f32 v2, v227, 0, v2
    v_fma_f32 v2, v228, 0, v2
    v_fma_f32 v2, v229, 0, v2
    v_fma_f32 v2, v230, 0, v2
    v_fma_f32 v2, v231, 0, v2
    v_cmp_nlt_f32 vcc, v2, v3
    v_max3_f32 v2, |v224|, |v225|, |v226|
    v_max3_f32 v3, |v227|, |v228|, |v229|
    v_max3_f32 v2, v2, |v230|, |v231|
    v_max_f32 v2, v2, v3
    s_cbranch_vccnz L_fallback
    v_cmp_gt_f32 vcc, 0x06000000, v2
    s_nop 3
    s_cbranch_vccnz L_fallback
L_fin:
    v_mul_f32 v224, v224, v5
    v_mul_f32 v225, v225, v5
    v_mul_f32 v226, v226, v5
    v_mul_f32 v227, v227, v5
    v_mul_f32 v228, v228, v5
    v_mul_f32 v229, v229, v5
    v_mul_f32 v230, v230, v5
    v_mul_f32 v231, v231, v5
    v_cvt_pk_bf16_f32 v176, v224, v225
    v_cvt_pk_bf16_f32 v177, v226, v227
    v_cvt_pk_bf16_f32 v178, v228, v229
    v_cvt_pk_bf16_f32 v179, v230, v231
    v_min_u32 v176, -2, v176
    buffer_store_dwordx4 v[176:179], v6, s[32:35], s51 offen sc1
    s_lshl1_add_u32 s52, s48, s53
    s_lshl_b32 s52, s52, 11
    s_add_u32 s80, s80, s52
    s_add_u32 s80, s80, 8503296
    s_add_u32 s89, s80, 8192
    s_add_u32 s95, s80, 16384
    s_add_u32 s96, s80, 24576
    s_waitcnt lgkmcnt(9)
    v_mfma_f32_32x32x16_bf16 v[128:143], v[144:147], v[160:163], v[128:143]
    s_waitcnt lgkmcnt(6)
    v_mfma_f32_32x32x16_bf16 v[128:143], v[148:151], v[164:167], v[128:143]
    s_waitcnt lgkmcnt(3)
    v_mfma_f32_32x32x16_bf16 v[128:143], v[152:155], v[168:171], v[128:143]
    s_waitcnt lgkmcnt(0)
    v_mfma_f32_32x32x16_bf16 v[128:143], v[156:159], v[172:175], v[128:143]
    s_lshl_b32 s52, s53, 12
    v_add_u32 v110, s52, v1
    v_xor_b32 v111, 64, v110
    v_add_u32 v100, 0x10000, v110
    v_add_u32 v101, 0x10000, v111
    s_waitcnt vmcnt(1)
    s_barrier
    buffer_load_dwordx4 v[32:35], v6, s[32:35], s80 offen offset:0 sc1
    buffer_load_dwordx4 v[36:39], v6, s[32:35], s80 offen offset:1024 sc1
    buffer_load_dwordx4 v[40:43], v6, s[32:35], s89 offen offset:0 sc1
    buffer_load_dwordx4 v[44:47], v6, s[32:35], s89 offen offset:1024 sc1
    buffer_load_dwordx4 v[48:51], v6, s[32:35], s95 offen offset:0 sc1
    buffer_load_dwordx4 v[52:55], v6, s[32:35], s95 offen offset:1024 sc1
    buffer_load_dwordx4 v[56:59], v6, s[32:35], s96 offen offset:0 sc1
    buffer_load_dwordx4 v[60:63], v6, s[32:35], s96 offen offset:1024 sc1
    ds_read_b64_tr_b16 v[192:193], v110 offset:16384
    ds_read_b64_tr_b16 v[194:195], v110 offset:17408
    ds_read_b64_tr_b16 v[196:197], v111 offset:16384
    ds_read_b64_tr_b16 v[198:199], v111 offset:17408
    ds_read_b64_tr_b16 v[200:201], v110 offset:18432
    ds_read_b64_tr_b16 v[202:203], v110 offset:19456
    ds_read_b64_tr_b16 v[204:205], v111 offset:18432
    ds_read_b64_tr_b16 v[206:207], v111 offset:19456
    ds_read_b64_tr_b16 v[208:209], v110 offset:32768
    ds_read_b64_tr_b16 v[210:211], v110 offset:33792
    ds_read_b64_tr_b16 v[212:213], v111 offset:32768
    ds_read_b64_tr_b16 v[214:215], v111 offset:33792
    ds_read_b64_tr_b16 v[216:217], v110 offset:34816
    ds_read_b64_tr_b16 v[218:219], v110 offset:35840
    ds_read_b64_tr_b16 v[220:221], v111 offset:34816
    ds_read_b64_tr_b16 v[222:223], v111 offset:35840
    ds_read_b64_tr_b16 v[224:225], v100 offset:16384
    ds_read_b64_tr_b16 v[226:227], v100 offset:17408
    ds_read_b64_tr_b16 v[228:229], v101 offset:16384
    ds_read_b64_tr_b16 v[230:231], v101 offset:17408
    ds_read_b64_tr_b16 v[232:233], v100 offset:18432
    ds_read_b64_tr_b16 v[234:235], v100 offset:19456
    ds_read_b64_tr_b16 v[236:237], v101 offset:18432
    ds_read_b64_tr_b16 v[238:239], v101 offset:19456
    ds_read_b64_tr_b16 v[240:241], v100 offset:32768
    ds_read_b64_tr_b16 v[242:243], v100 offset:33792
    ds_read_b64_tr_b16 v[244:245], v101 offset:32768
    ds_read_b64_tr_b16 v[246:247], v101 offset:33792
    ds_read_b64_tr_b16 v[248:249], v100 offset:34816
    ds_read_b64_tr_b16 v[250:251], v100 offset:35840
    ds_read_b64_tr_b16 v[252:253], v101 offset:34816
    ds_read_b64_tr_b16 v[254:255], v101 offset:35840
    v_lshrrev_b32 v102, 4, v6
    v_lshrrev_b32 v99, 10, v19
    v_and_b32 v103, 7, v102
    v_and_b32 v2, 31, v102
    v_lshrrev_b32 v3, 5, v102
    v_xor_b32 v3, v3, v103
    v_lshlrev_b32 v2, 8, v2
    s_lshr_b32 s51, s46, 1
    s_lshl_b32 s51, s51, 13
    s_lshl_b32 s53, s53, 7
    s_add_u32 s51, s51, s53
    v_add_u32 v2, s51, v2
    v_lshl_add_u32 v104, v3, 4, v2
    v_xor_b32 v80, 0x80, v104
    v_add_u32 v80, 81920, v80
    v_xor_b32 v105, 32, v104
    v_xor_b32 v81, 32, v80
    v_xor_b32 v106, 64, v104
    v_xor_b32 v82, 64, v80
    v_xor_b32 v107, 96, v104
    v_xor_b32 v83, 96, v80
    v_and_b32 v3, 7, v99
    v_lshlrev_b32 v103, 1, v103
    v_xor_b32 v103, v103, v3
    v_lshlrev_b32 v2, 8, v99
    v_lshl_add_u32 v108, v103, 4, v2
    v_xor_b32 v109, 16, v108
    v_add_u32 v84, 81920, v108
    v_add_u32 v85, 81920, v109
    v_lshlrev_b32 v112, 16, v28
    v_and_b32 v113, 0xffff0000, v28
    v_lshlrev_b32 v114, 16, v29
    v_and_b32 v115, 0xffff0000, v29
    v_lshlrev_b32 v116, 16, v30
    v_and_b32 v117, 0xffff0000, v30
    v_lshlrev_b32 v118, 16, v31
    v_and_b32 v119, 0xffff0000, v31
    s_waitcnt lgkmcnt(0)
    s_waitcnt vmcnt(7)
L_oc0:
    v_cmp_eq_u32 vcc, -1, v32
    s_nop 1
    s_cbranch_vccz L_ok0
    s_call_b64 s[100:101], L_refresh
    s_cbranch_scc0 L_oc0
L_ok0:
    v_mfma_f32_32x32x16_bf16 v[128:143], v[192:195], v[32:35], v[128:143]
    v_mfma_f32_32x32x16_bf16 v[64:79], v[196:199], v[32:35], 0
    s_waitcnt vmcnt(6)
L_oc1:
    v_cmp_eq_u32 vcc, -1, v36
    s_nop 1
    s_cbranch_vccz L_ok1
    s_call_b64 s[100:101], L_refresh
    s_cbranch_scc0 L_oc1
L_ok1:
    v_mfma_f32_32x32x16_bf16 v[128:143], v[200:203], v[36:39], v[128:143]
    v_mfma_f32_32x32x16_bf16 v[64:79], v[204:207], v[36:39], v[64:79]
    s_waitcnt vmcnt(5)
L_oc2:
    v_cmp_eq_u32 vcc, -1, v40
    s_nop 1
    s_cbranch_vccz L_ok2
    s_call_b64 s[100:101], L_refresh
    s_cbranch_scc0 L_oc2
L_ok2:
    v_mfma_f32_32x32x16_bf16 v[128:143], v[208:211], v[40:43], v[128:143]
    v_mfma_f32_32x32x16_bf16 v[64:79], v[212:215], v[40:43], v[64:79]
    s_waitcnt vmcnt(4)
L_oc3:
    v_cmp_eq_u32 vcc, -1, v44
    s_nop 1
    s_cbranch_vccz L_ok3
    s_call_b64 s[100:101], L_refresh
    s_cbranch_scc0 L_oc3
L_ok3:
    v_mfma_f32_32x32x16_bf16 v[128:143], v[216:219], v[44:47], v[128:143]
    v_mfma_f32_32x32x16_bf16 v[64:79], v[220:223], v[44:47], v[64:79]
    s_waitcnt vmcnt(3)
L_oc4:
    v_cmp_eq_u32 vcc, -1, v48
    s_nop 1
    s_cbranch_vccz L_ok4
    s_call_b64 s[100:101], L_refresh
    s_cbranch_scc0 L_oc4
L_ok4:
    v_mfma_f32_32x32x16_bf16 v[128:143], v[224:227], v[48:51], v[128:143]
    v_mfma_f32_32x32x16_bf16 v[64:79], v[228:231], v[48:51], v[64:79]
    s_waitcnt vmcnt(2)
L_oc5:
    v_cmp_eq_u32 vcc, -1, v52
    s_nop 1
    s_cbranch_vccz L_ok5
    s_call_b64 s[100:101], L_refresh
    s_cbranch_scc0 L_oc5
L_ok5:
    v_mfma_f32_32x32x16_bf16 v[128:143], v[232:235], v[52:55], v[128:143]
    v_mfma_f32_32x32x16_bf16 v[64:79], v[236:239], v[52:55], v[64:79]
    s_waitcnt vmcnt(1)
L_oc6:
    v_cmp_eq_u32 vcc, -1, v56
    s_nop 1
    s_cbranch_vccz L_ok6
    s_call_b64 s[100:101], L_refresh
    s_cbranch_scc0 L_oc6
L_ok6:
    v_mfma_f32_32x32x16_bf16 v[128:143], v[240:243], v[56:59], v[128:143]
    v_mfma_f32_32x32x16_bf16 v[64:79], v[244:247], v[56:59], v[64:79]
    s_waitcnt vmcnt(0)
L_oc7:
    v_cmp_eq_u32 vcc, -1, v60
    s_nop 1
    s_cbranch_vccz L_ok7
    s_call_b64 s[100:101], L_refresh
    s_cbranch_scc0 L_oc7
L_ok7:
    v_mfma_f32_32x32x16_bf16 v[128:143], v[248:251], v[60:63], v[128:143]
    v_mfma_f32_32x32x16_bf16 v[64:79], v[252:255], v[60:63], v[64:79]
    s_nop 10
    ds_write_b128 v104, v[128:131]
    ds_write_b128 v105, v[132:135]
    ds_write_b128 v106, v[136:139]
    ds_write_b128 v107, v[140:143]
    ds_write_b128 v80, v[64:67]
    ds_write_b128 v81, v[68:71]
    ds_write_b128 v82, v[72:75]
    ds_write_b128 v83, v[76:79]
    s_waitcnt lgkmcnt(0)
    s_barrier
    ds_read_b128 v[32:35], v108 offset:0
    ds_read_b128 v[36:39], v109 offset:0
    ds_read_b128 v[40:43], v108 offset:16384
    ds_read_b128 v[44:47], v109 offset:16384
    ds_read_b128 v[48:51], v84 offset:0
    ds_read_b128 v[52:55], v85 offset:0
    ds_read_b128 v[56:59], v84 offset:16384
    ds_read_b128 v[60:63], v85 offset:16384
    s_waitcnt lgkmcnt(6)
    v_add_f32 v112, v112, v32
    v_add_f32 v113, v113, v33
    v_add_f32 v114, v114, v34
    v_add_f32 v115, v115, v35
    v_add_f32 v116, v116, v36
    v_add_f32 v117, v117, v37
    v_add_f32 v118, v118, v38
    v_add_f32 v119, v119, v39
    s_waitcnt lgkmcnt(4)
    v_add_f32 v112, v112, v40
    v_add_f32 v113, v113, v41
    v_add_f32 v114, v114, v42
    v_add_f32 v115, v115, v43
    v_add_f32 v116, v116, v44
    v_add_f32 v117, v117, v45
    v_add_f32 v118, v118, v46
    v_add_f32 v119, v119, v47
    s_waitcnt lgkmcnt(2)
    v_add_f32 v112, v112, v48
    v_add_f32 v113, v113, v49
    v_add_f32 v114, v114, v50
    v_add_f32 v115, v115, v51
    v_add_f32 v116, v116, v52
    v_add_f32 v117, v117, v53
    v_add_f32 v118, v118, v54
    v_add_f32 v119, v119, v55
    s_waitcnt lgkmcnt(0)
    v_add_f32 v112, v112, v56
    v_add_f32 v113, v113, v57
    v_add_f32 v114, v114, v58
    v_add_f32 v115, v115, v59
    v_add_f32 v116, v116, v60
    v_add_f32 v117, v117, v61
    v_add_f32 v118, v118, v62
    v_add_f32 v119, v119, v63
    v_cvt_pk_bf16_f32 v28, v112, v113
    v_cvt_pk_bf16_f32 v29, v114, v115
    v_cvt_pk_bf16_f32 v30, v116, v117
    v_cvt_pk_bf16_f32 v31, v118, v119
    buffer_store_dwordx4 v[28:31], v19, s[28:31], s55 offen nt
    s_or_b32 s51, s2, s46
    s_cmp_lg_u32 s51, 0
    s_cbranch_scc1 L_noep
    s_mov_b32 s51, 21020672
    s_mov_b64 exec, 1
    buffer_store_dword v124, off, s[32:35], s51 sc1
    s_mov_b64 exec, -1
L_noep:
    s_endpgm
    .p2align 6
    s_nop 0
L_burst:
    s_barrier
    v_exp_f32 v192, v192
    v_exp_f32 v193, v193
    v_exp_f32 v194, v194
    v_exp_f32 v195, v195
    v_mfma_f32_32x32x16_bf16 v[208:223], v[96:99], v[24:27], v[240:255]
    v_exp_f32 v196, v196
    v_exp_f32 v197, v197
    v_exp_f32 v198, v198
    v_exp_f32 v199, v199
    v_exp_f32 v200, v200
    v_exp_f32 v201, v201
    v_mfma_f32_32x32x16_bf16 v[224:239], v[32:35], v[184:187], v[224:239]
    v_exp_f32 v202, v202
    v_exp_f32 v203, v203
    v_exp_f32 v204, v204
    v_exp_f32 v205, v205
    v_exp_f32 v206, v206
    v_exp_f32 v207, v207
    v_mfma_f32_32x32x16_bf16 v[224:239], v[36:39], v[188:191], v[224:239]
    v_cvt_pk_bf16_f32 v176, v192, v193
    v_cvt_pk_bf16_f32 v177, v194, v195
    v_cvt_pk_bf16_f32 v178, v196, v197
    v_cvt_pk_bf16_f32 v179, v198, v199
    v_cvt_pk_bf16_f32 v180, v200, v201
    v_cvt_pk_bf16_f32 v181, v202, v203
    v_cvt_pk_bf16_f32 v182, v204, v205
    v_cvt_pk_bf16_f32 v183, v206, v207
    v_mfma_f32_32x32x16_bf16 v[128:143], v[144:147], v[160:163], v[128:143]
    v_exp_f32 v208, v208
    v_exp_f32 v209, v209
    v_exp_f32 v210, v210
    v_exp_f32 v211, v211
    v_mfma_f32_32x32x16_bf16 v[192:207], v[100:103], v[24:27], v[240:255]
    v_exp_f32 v212, v212
    v_exp_f32 v213, v213
    v_exp_f32 v214, v214
    v_exp_f32 v215, v215
    v_exp_f32 v216, v216
    v_exp_f32 v217, v217
    v_mfma_f32_32x32x16_bf16 v[224:239], v[40:43], v[176:179], v[224:239]
    v_exp_f32 v218, v218
    v_exp_f32 v219, v219
    v_exp_f32 v220, v220
    v_exp_f32 v221, v221
    v_exp_f32 v222, v222
    v_exp_f32 v223, v223
    v_mfma_f32_32x32x16_bf16 v[224:239], v[44:47], v[180:183], v[224:239]
    v_cvt_pk_bf16_f32 v184, v208, v209
    v_cvt_pk_bf16_f32 v185, v210, v211
    v_cvt_pk_bf16_f32 v186, v212, v213
    v_cvt_pk_bf16_f32 v187, v214, v215
    v_cvt_pk_bf16_f32 v188, v216, v217
    v_cvt_pk_bf16_f32 v189, v218, v219
    v_cvt_pk_bf16_f32 v190, v220, v221
    v_cvt_pk_bf16_f32 v191, v222, v223
    v_mfma_f32_32x32x16_bf16 v[128:143], v[148:151], v[164:167], v[128:143]
    v_exp_f32 v192, v192
    v_exp_f32 v193, v193
    v_exp_f32 v194, v194
    v_exp_f32 v195, v195
    v_mfma_f32_32x32x16_bf16 v[208:223], v[104:107], v[24:27], v[240:255]
    v_exp_f32 v196, v196
    v_exp_f32 v197, v197
    v_exp_f32 v198, v198
    v_exp_f32 v199, v199
    v_exp_f32 v200, v200
    v_exp_f32 v201, v201
    v_mfma_f32_32x32x16_bf16 v[224:239], v[48:51], v[184:187], v[224:239]
    v_exp_f32 v202, v202
    v_exp_f32 v203, v203
    v_exp_f32 v204, v204
    v_exp_f32 v205, v205
    v_exp_f32 v206, v206
    v_exp_f32 v207, v207
    v_mfma_f32_32x32x16_bf16 v[224:239], v[52:55], v[188:191], v[224:239]
    v_cvt_pk_bf16_f32 v176, v192, v193
    v_cvt_pk_bf16_f32 v177, v194, v195
    v_cvt_pk_bf16_f32 v178, v196, v197
    v_cvt_pk_bf16_f32 v179, v198, v199
    v_cvt_pk_bf16_f32 v180, v200, v201
    v_cvt_pk_bf16_f32 v181, v202, v203
    v_cvt_pk_bf16_f32 v182, v204, v205
    v_cvt_pk_bf16_f32 v183, v206, v207
    v_mfma_f32_32x32x16_bf16 v[128:143], v[152:155], v[168:171], v[128:143]
    v_exp_f32 v208, v208
    v_exp_f32 v209, v209
    v_exp_f32 v210, v210
    v_exp_f32 v211, v211
    v_mfma_f32_32x32x16_bf16 v[192:207], v[108:111], v[24:27], v[240:255]
    v_exp_f32 v212, v212
    v_exp_f32 v213, v213
    v_exp_f32 v214, v214
    v_exp_f32 v215, v215
    v_exp_f32 v216, v216
    v_exp_f32 v217, v217
    v_mfma_f32_32x32x16_bf16 v[224:239], v[56:59], v[176:179], v[224:239]
    v_exp_f32 v218, v218
    v_exp_f32 v219, v219
    v_exp_f32 v220, v220
    v_exp_f32 v221, v221
    v_exp_f32 v222, v222
    v_exp_f32 v223, v223
    v_mfma_f32_32x32x16_bf16 v[224:239], v[60:63], v[180:183], v[224:239]
    v_cvt_pk_bf16_f32 v184, v208, v209
    v_cvt_pk_bf16_f32 v185, v210, v211
    v_cvt_pk_bf16_f32 v186, v212, v213
    v_cvt_pk_bf16_f32 v187, v214, v215
    v_cvt_pk_bf16_f32 v188, v216, v217
    v_cvt_pk_bf16_f32 v189, v218, v219
    v_cvt_pk_bf16_f32 v190, v220, v221
    v_cvt_pk_bf16_f32 v191, v222, v223
    v_mfma_f32_32x32x16_bf16 v[128:143], v[156:159], v[172:175], v[128:143]
    s_waitcnt vmcnt(5)
    s_cbranch_scc1 L_bret
    s_barrier
L_bret:
    s_setpc_b64 s[78:79]
L_refresh:
    s_waitcnt vmcnt(0)
    s_sleep 1
    v_cmp_eq_u32 vcc, -1, v32
    s_nop 1
    s_cbranch_vccz L_rf0
    buffer_load_dwordx4 v[32:35], v6, s[32:35], s80 offen offset:0 sc1
L_rf0:
    v_cmp_eq_u32 vcc, -1, v36
    s_nop 1
    s_cbranch_vccz L_rf1
    buffer_load_dwordx4 v[36:39], v6, s[32:35], s80 offen offset:1024 sc1
L_rf1:
    v_cmp_eq_u32 vcc, -1, v40
    s_nop 1
    s_cbranch_vccz L_rf2
    buffer_load_dwordx4 v[40:43], v6, s[32:35], s89 offen offset:0 sc1
L_rf2:
    v_cmp_eq_u32 vcc, -1, v44
    s_nop 1
    s_cbranch_vccz L_rf3
    buffer_load_dwordx4 v[44:47], v6, s[32:35], s89 offen offset:1024 sc1
L_rf3:
    v_cmp_eq_u32 vcc, -1, v48
    s_nop 1
    s_cbranch_vccz L_rf4
    buffer_load_dwordx4 v[48:51], v6, s[32:35], s95 offen offset:0 sc1
L_rf4:
    v_cmp_eq_u32 vcc, -1, v52
    s_nop 1
    s_cbranch_vccz L_rf5
    buffer_load_dwordx4 v[52:55], v6, s[32:35], s95 offen offset:1024 sc1
L_rf5:
    v_cmp_eq_u32 vcc, -1, v56
    s_nop 1
    s_cbranch_vccz L_rf6
    buffer_load_dwordx4 v[56:59], v6, s[32:35], s96 offen offset:0 sc1
L_rf6:
    v_cmp_eq_u32 vcc, -1, v60
    s_nop 1
    s_cbranch_vccz L_rf7
    buffer_load_dwordx4 v[60:63], v6, s[32:35], s96 offen offset:1024 sc1
L_rf7:
    s_waitcnt vmcnt(0)
    s_max_u32 s66, s66, 1
    s_sub_u32 s66, s66, 1
    s_cmp_eq_u32 s66, 0
    s_setpc_b64 s[100:101]
L_fallback:
    s_mov_b32 s81, 1
    s_mov_b32 s60, 0
    s_mov_b32 s62, s56
    v_mov_b32 v2, 0xff800000
L_maxloop:
    buffer_load_dwordx4 v[96:99], v6, s[32:35], s62 offen sc1
    s_waitcnt vmcnt(0)
    v_mfma_f32_32x32x16_bf16 v[192:207], v[96:99], v[24:27], 0
    s_nop 7
    s_nop 3
    v_max3_f32 v2, v2, v192, v193
    v_max3_f32 v2, v2, v194, v195
    v_max3_f32 v2, v2, v196, v197
    v_max3_f32 v2, v2, v198, v199
    v_max3_f32 v2, v2, v200, v201
    v_max3_f32 v2, v2, v202, v203
    v_max3_f32 v2, v2, v204, v205
    v_max3_f32 v2, v2, v206, v207
    s_add_u32 s62, s62, 1024
    s_add_u32 s60, s60, 1
    s_cmp_lt_u32 s60, 64
    s_cbranch_scc1 L_maxloop
    v_mov_b32 v3, v2
    s_nop 1
    v_permlane32_swap_b32 v2, v3
    s_nop 0
    v_max_f32 v2, v2, v3
    v_sub_f32 v240, 0, v2
    v_sub_f32 v241, 0, v2
    v_sub_f32 v242, 0, v2
    v_sub_f32 v243, 0, v2
    v_sub_f32 v244, 0, v2
    v_sub_f32 v245, 0, v2
    v_sub_f32 v246, 0, v2
    v_sub_f32 v247, 0, v2
    v_sub_f32 v248, 0, v2
    v_sub_f32 v249, 0, v2
    v_sub_f32 v250, 0, v2
    v_sub_f32 v251, 0, v2
    v_sub_f32 v252, 0, v2
    v_sub_f32 v253, 0, v2
    v_sub_f32 v254, 0, v2
    v_sub_f32 v255, 0, v2
    v_mov_b32 v224, 0
    v_mov_b32 v225, 0
    v_mov_b32 v226, 0
    v_mov_b32 v227, 0
    v_mov_b32 v228, 0
    v_mov_b32 v229, 0
    v_mov_b32 v230, 0
    v_mov_b32 v231, 0
    v_mov_b32 v232, 0
    v_mov_b32 v233, 0
    v_mov_b32 v234, 0
    v_mov_b32 v235, 0
    v_mov_b32 v236, 0
    v_mov_b32 v237, 0
    v_mov_b32 v238, 0
    v_mov_b32 v239, 0
    s_mov_b32 s60, 0
L_fbloop:
    s_add_u32 s62, s56, 2097152
    buffer_load_dwordx4 v[96:99], v6, s[32:35], s56 offen sc1
    s_mov_b64 exec, s[70:71]
    buffer_load_dwordx4 v[32:35], v6, s[32:35], s62 offen sc1
    buffer_load_dwordx4 v[36:39], v6, s[32:35], s62 offen offset:256 sc1
    s_mov_b64 exec, -1
    s_waitcnt vmcnt(0)
    v_mfma_f32_32x32x16_bf16 v[192:207], v[96:99], v[24:27], v[240:255]
    s_nop 7
    s_nop 3
    v_exp_f32 v192, v192
    v_exp_f32 v193, v193
    v_exp_f32 v194, v194
    v_exp_f32 v195, v195
    v_exp_f32 v196, v196
    v_exp_f32 v197, v197
    v_exp_f32 v198, v198
    v_exp_f32 v199, v199
    v_exp_f32 v200, v200
    v_exp_f32 v201, v201
    v_exp_f32 v202, v202
    v_exp_f32 v203, v203
    v_exp_f32 v204, v204
    v_exp_f32 v205, v205
    v_exp_f32 v206, v206
    v_exp_f32 v207, v207
    s_nop 0
    v_cvt_pk_bf16_f32 v176, v192, v193
    v_cvt_pk_bf16_f32 v177, v194, v195
    v_cvt_pk_bf16_f32 v178, v196, v197
    v_cvt_pk_bf16_f32 v179, v198, v199
    v_cvt_pk_bf16_f32 v180, v200, v201
    v_cvt_pk_bf16_f32 v181, v202, v203
    v_cvt_pk_bf16_f32 v182, v204, v205
    v_cvt_pk_bf16_f32 v183, v206, v207
    s_nop 1
    v_mfma_f32_32x32x16_bf16 v[224:239], v[32:35], v[176:179], v[224:239]
    v_mfma_f32_32x32x16_bf16 v[224:239], v[36:39], v[180:183], v[224:239]
    s_add_u32 s56, s56, 1024
    s_add_u32 s60, s60, 1
    s_cmp_lt_u32 s60, 64
    s_cbranch_scc1 L_fbloop
    s_nop 7
    s_nop 3
    v_rcp_f32 v5, v232
    s_nop 0
    s_branch L_fin
L_end:
    s_endpgm
.section .rodata,"a"
.p2align 6
.amdhsa_kernel parallel_sum__softmax_full_mha__swiglu_ffn__prompt_kernel
  .amdhsa_next_free_vgpr 256
  .amdhsa_next_free_sgpr 102
  .amdhsa_accum_offset 256
  .amdhsa_group_segment_fixed_size 0
  .amdhsa_kernarg_size 80
  .amdhsa_user_sgpr_count 2
  .amdhsa_user_sgpr_kernarg_segment_ptr 1
  .amdhsa_system_sgpr_workgroup_id_x 1
  .amdhsa_float_denorm_mode_32 3
.end_amdhsa_kernel
```
